```python
import torch

def _softmax(x, axis=-1):
    return torch.softmax(x, dim=axis)
def _gelu(x):
    return torch.nn.functional.gelu(x, approximate="tanh")
def _silu(x):
    return torch.nn.functional.silu(x)
def _sigmoid(x):
    return torch.sigmoid(x)
def _layernorm(x, axis=-1, eps=1e-5):
    m = x.mean(dim=axis, keepdim=True)
    v = x.var(dim=axis, keepdim=True, unbiased=False)
    return (x - m) / torch.sqrt(v + eps)
def _scatter_add(tgt, idx, src, axis=0):
    return tgt.clone().index_add_(axis, idx, src)
def _segment_sum(src, seg, n):
    out = torch.zeros((n,) + src.shape[1:], dtype=src.dtype)
    return out.index_add_(0, seg, src)
def _pad(x, pw):
    flat = tuple(v for pair in reversed(pw) for v in pair)
    return torch.nn.functional.pad(x, flat)

kernel_name = 'parallel_sum__sliding_block_cached__geglu_ffn__decode'

def setup_inputs():

    _w = (lambda a: (lambda t: t.to(torch.bfloat16) if t.is_floating_point() else t)(torch.as_tensor(a)))
    def _A_setup():
        B, Sq, D = 8, 1, 576
        Hq, Hkv, Sk, Dh = 32, 16, 8192, 128
        assert Hq % Hkv == 0, (Hq, Hkv)
        return {
            "x": _w((lambda *s: torch.randn(*s, dtype=torch.bfloat16) * 0.05)(B, Sq, D)),
            "k_cache": _w((lambda *s: torch.randn(*s, dtype=torch.bfloat16) * 3.2)(B, Hkv, Sk, Dh)),
            "v_cache": _w((lambda *s: torch.randn(*s, dtype=torch.bfloat16) * 1.6)(B, Hkv, Sk, Dh)),
            "wq": _w((lambda *s: torch.randn(*s, dtype=torch.bfloat16) * 3.2)(D, Hq * Dh) * (D ** -0.5)),
            "wo": _w((lambda *s: torch.randn(*s, dtype=torch.bfloat16) * 1.6)(Hq * Dh, D) * ((Hq * Dh) ** -0.5)),
        }
    _A_in = _A_setup()

    def _B_setup():
        B, S, D, F = 8, 1, 576, 4608
        return {
            "x": _w((lambda *s: torch.randn(*s, dtype=torch.bfloat16) * 0.05)(B, S, D)),
            "w_gate": _w((lambda *s: torch.randn(*s, dtype=torch.bfloat16) * 0.05)(D, F)),
            "w_up": _w((lambda *s: torch.randn(*s, dtype=torch.bfloat16) * 0.05)(D, F)),
            "w_down": _w((lambda *s: torch.randn(*s, dtype=torch.bfloat16) * 0.05)(F, D)),
        }
    _B_in = _B_setup()

    return {
        "A_x": _A_in["x"],
        "A_k_cache": _A_in["k_cache"],
        "A_v_cache": _A_in["v_cache"],
        "A_wq": _A_in["wq"],
        "A_wo": _A_in["wo"],
        "B_x": _B_in["x"],
        "B_w_gate": _B_in["w_gate"],
        "B_w_up": _B_in["w_up"],
        "B_w_down": _B_in["w_down"],
    }

def reference(A_x, A_k_cache, A_v_cache, A_wq, A_wo, B_x, B_w_gate, B_w_up, B_w_down):
    def _A_ref(x, k_cache, v_cache, wq, wo):
        B, Sq, D = x.shape
        Hq, Dh = 32, 128
        Hkv, Sk = k_cache.shape[1], k_cache.shape[2]
        W = min(4096, max(256, Sk // 4))
        rep = Hq // Hkv
        q = (lambda x, *d: x.permute(*d))((x @ wq).reshape(B, Sq, Hq, Dh), 0, 2, 1, 3)
        k = (lambda x, n, axis: torch.repeat_interleave(x, n, dim=axis))(k_cache[:, :, Sk - W:, :], rep, axis=1)
        v = (lambda x, n, axis: torch.repeat_interleave(x, n, dim=axis))(v_cache[:, :, Sk - W:, :], rep, axis=1)
        scores = torch.einsum("bhqd,bhkd->bhqk", q, k) * (Dh ** -0.5)
        p = _softmax(scores, axis=-1)
        o = torch.einsum("bhqk,bhkd->bhqd", p, v)
        return (lambda x, *d: x.permute(*d))(o, 0, 2, 1, 3).reshape(B, Sq, Hq * Dh) @ wo

    def _B_ref(x, w_gate, w_up, w_down):
        return (_gelu(x @ w_gate) * (x @ w_up)) @ w_down

    x = A_x
    xn = _layernorm(x, axis=-1)
    return x + _A_ref(xn, A_k_cache, A_v_cache, A_wq, A_wo) + _B_ref(xn, B_w_gate, B_w_up, B_w_down)
```

```asm
; @launch grid=(256,1,1) block=(512,1,1) lds=158208
.amdgcn_target "amdgcn-amd-amdhsa--gfx950"
.text
.globl parallel_sum__sliding_block_cached__geglu_ffn__decode_kernel
.p2align 8
.type parallel_sum__sliding_block_cached__geglu_ffn__decode_kernel,@function
parallel_sum__sliding_block_cached__geglu_ffn__decode_kernel:
    s_cmp_ge_u32 s2, 256
    s_cbranch_scc1 L_end
    s_load_dwordx16 s[16:31], s[0:1], 0
    s_load_dwordx8 s[32:39], s[0:1], 64
    v_lshrrev_b32 v1, 6, v0
    v_and_b32 v0, 63, v0
    v_readfirstlane_b32 s3, v1
    s_xor_b32 s3, s3, 4
    s_and_b32 s8, s2, 15
    s_lshr_b32 s9, s2, 4
    s_sub_u32 s12, s9, 13
    s_lshl_b32 s10, s8, 2
    s_add_u32 s10, s10, s9
    s_sub_u32 s10, s10, 9
    s_and_b32 s5, s2, 7
    s_bfe_u32 s6, s2, 0x10003
    s_lshl_b32 s11, s5, 1
    s_add_u32 s11, s11, s6
    s_mul_i32 s79, s5, 9
    s_add_u32 s79, s79, s9
    s_cmp_ge_u32 s3, 4
    s_cbranch_scc1 L_aux
    v_lshrrev_b32 v1, 3, v0
    v_and_b32 v2, 7, v0
    v_and_b32 v3, 2, v1
    s_and_b32 s5, s3, 1
    s_lshl_b32 s5, s5, 2
    v_or_b32 v3, s5, v3
    v_xor_b32 v2, v2, v3
    v_lshlrev_b32 v2, 4, v2
    s_lshl_b32 m0, s3, 10
    s_mov_b32 s43, 0x20000
    s_lshl_b32 s60, s79, 7
    s_lshl_b32 s5, s10, 7
    s_movk_i32 s7, 9216
    s_mov_b32 s42, 5308416
    s_cmp_ge_u32 s2, 144
    s_cselect_b32 s60, s5, s60
    s_cselect_b32 s7, 8192, s7
    s_cselect_b32 s42, 4718592, s42
    s_mul_i32 s5, s11, 331776
    s_mul_i32 s6, s12, 384
    s_add_u32 s5, s5, s6
    s_lshl_b32 s62, s7, 5
    s_movk_i32 s64, 4096
    s_cmp_ge_u32 s2, 208
    s_cselect_b32 s60, s5, s60
    s_cselect_b32 s7, 1152, s7
    s_cselect_b32 s42, 5308416, s42
    s_cselect_b32 s63, 36608, s62
    s_cselect_b32 s62, 128, s62
    s_cselect_b32 s65, -45056, s64
    s_cselect_b32 s64, 24576, s64
    s_mul_i32 s5, s3, s7
    s_lshl_b32 s5, s5, 3
    s_add_u32 s72, s60, s5
    v_mad_u32_u24 v14, v1, s7, v2
    s_bitcmp1_b32 s2, 3
    s_waitcnt lgkmcnt(0)
    s_cselect_b64 s[40:41], s[30:31], s[28:29]
    s_cmp_ge_u32 s2, 144
    s_cselect_b64 s[40:41], s[22:23], s[40:41]
    s_cmp_ge_u32 s2, 208
    s_cselect_b64 s[40:41], s[32:33], s[40:41]
    buffer_load_dwordx4 v14, s[40:43], s72 offen nt lds
    s_add_u32 s72, s72, s62
    s_add_u32 m0, m0, s64
    s_nop 0
    buffer_load_dwordx4 v14, s[40:43], s72 offen nt lds
    s_add_u32 s72, s72, s62
    s_add_u32 m0, m0, s64
    s_nop 0
    buffer_load_dwordx4 v14, s[40:43], s72 offen nt lds
    s_add_u32 s72, s72, s63
    s_add_u32 m0, m0, s65
    s_nop 0
    buffer_load_dwordx4 v14, s[40:43], s72 offen nt lds
    s_add_u32 s72, s72, s62
    s_add_u32 m0, m0, s64
    s_nop 0
    buffer_load_dwordx4 v14, s[40:43], s72 offen nt lds
    s_add_u32 s72, s72, s62
    s_add_u32 m0, m0, s64
    s_nop 0
    buffer_load_dwordx4 v14, s[40:43], s72 offen nt lds
    s_add_u32 s72, s72, s63
    s_add_u32 m0, m0, s65
    s_lshl_b32 s5, s3, 2
    s_add_u32 s5, s5, 145488
    v_mov_b32 v125, s5
    v_mov_b32 v127, 145504
    s_barrier
    s_waitcnt vmcnt(5)
    buffer_load_dwordx4 v14, s[40:43], s72 offen nt lds
    s_add_u32 s72, s72, s62
    s_add_u32 m0, m0, s64
    s_waitcnt vmcnt(5)
    buffer_load_dwordx4 v14, s[40:43], s72 offen nt lds
    s_add_u32 s72, s72, s62
    s_add_u32 m0, m0, s64
    s_waitcnt vmcnt(5)
    buffer_load_dwordx4 v14, s[40:43], s72 offen nt lds
    s_add_u32 s72, s72, s63
    s_add_u32 m0, m0, s65
    s_waitcnt vmcnt(5)
    buffer_load_dwordx4 v14, s[40:43], s72 offen nt lds
    s_add_u32 s72, s72, s62
    s_add_u32 m0, m0, s64
    v_mov_b32 v124, 2
    ds_write_b32 v125, v124
    ds_read_b32 v126, v127
    s_waitcnt vmcnt(5)
    buffer_load_dwordx4 v14, s[40:43], s72 offen nt lds
    s_add_u32 s72, s72, s62
    s_add_u32 m0, m0, s64
    s_waitcnt vmcnt(5)
    buffer_load_dwordx4 v14, s[40:43], s72 offen nt lds
    s_add_u32 s72, s72, s63
    s_add_u32 m0, m0, s65
    s_waitcnt vmcnt(5)
    buffer_load_dwordx4 v14, s[40:43], s72 offen nt lds
    s_add_u32 s72, s72, s62
    s_add_u32 m0, m0, s64
    s_waitcnt vmcnt(5)
    buffer_load_dwordx4 v14, s[40:43], s72 offen nt lds
    s_add_u32 s72, s72, s62
    s_add_u32 m0, m0, s64
    v_mov_b32 v124, 3
    ds_write_b32 v125, v124
    ds_read_b32 v126, v127
    s_waitcnt vmcnt(5)
    buffer_load_dwordx4 v14, s[40:43], s72 offen nt lds
    s_add_u32 s72, s72, s63
    s_add_u32 m0, m0, s65
    s_waitcnt vmcnt(5)
    buffer_load_dwordx4 v14, s[40:43], s72 offen nt lds
    s_add_u32 s72, s72, s62
    s_add_u32 m0, m0, s64
    s_waitcnt vmcnt(5)
    buffer_load_dwordx4 v14, s[40:43], s72 offen nt lds
    s_add_u32 s72, s72, s62
    s_add_u32 m0, m0, s64
    s_waitcnt vmcnt(5)
    buffer_load_dwordx4 v14, s[40:43], s72 offen nt lds
    s_add_u32 s72, s72, s63
    s_add_u32 m0, m0, s65
    v_mov_b32 v124, 4
    ds_write_b32 v125, v124
    ds_read_b32 v126, v127
    s_mov_b32 s48, s18
    s_mov_b32 s49, s19
    s_mov_b32 s50, 268435456
    s_mov_b32 s51, 0x20000
    s_lshr_b32 s60, s9, 1
    s_lshl_b32 s60, s60, 4
    s_add_u32 s60, s60, s8
    s_lshl_b32 s60, s60, 21
    s_and_b32 s61, s9, 1
    s_lshl_b32 s61, s61, 15
    s_add_u32 s60, s60, s61
    s_lshl_b32 s61, s3, 12
    s_add_u32 s60, s60, s61
    s_add_u32 s60, s60, 1572864
    v_mul_u32_u24 v123, 1152, v1
    v_add_u32 v123, v123, v2
    v_lshlrev_b32 v1, 4, v0
    v_lshrrev_b32 v68, 4, v0
    v_and_b32 v69, 15, v0
    v_lshlrev_b32 v70, 2, v68
    v_xor_b32 v70, v70, v69
    v_lshlrev_b32 v70, 4, v70
    v_lshl_add_u32 v2, v68, 8, v70
    v_xor_b32 v3, 16, v2
    v_xor_b32 v4, 32, v2
    v_xor_b32 v5, 48, v2
    s_xor_b32 s61, s60, 0
    s_waitcnt vmcnt(5)
    buffer_load_dwordx4 v[128:131], v2, s[48:51], s61 offen offset:0 nt
    s_waitcnt vmcnt(5)
    buffer_load_dwordx4 v[132:135], v3, s[48:51], s61 offen offset:1024 nt
    s_waitcnt vmcnt(5)
    buffer_load_dwordx4 v[136:139], v4, s[48:51], s61 offen offset:2048 nt
    s_waitcnt vmcnt(5)
    buffer_load_dwordx4 v[140:143], v5, s[48:51], s61 offen offset:3072 nt
    v_mov_b32 v124, 5
    ds_write_b32 v125, v124
    ds_read_b32 v126, v127
    s_xor_b32 s61, s60, 24576
    s_waitcnt vmcnt(5)
    buffer_load_dwordx4 v[144:147], v2, s[48:51], s61 offen offset:0 nt
    s_waitcnt vmcnt(5)
    s_mov_b64 exec, 1
    v_mov_b32 v68, 145480
    v_mov_b32 v69, 1
    ds_add_u32 v68, v69
    s_mov_b64 exec, -1
    s_waitcnt vmcnt(5)
    buffer_load_dwordx4 v[148:151], v3, s[48:51], s61 offen offset:1024 nt
    s_add_u32 s66, s40, s72
    s_bfe_u32 s66, s66, 0x30007
    s_cmp_eq_u32 s66, 3
    s_cselect_b32 s66, 1, 0
    s_cmp_ge_u32 s2, 208
    s_cselect_b32 s66, 0, s66
    s_waitcnt lgkmcnt(0)
    v_mov_b32 v126, s66
    ds_write_b32 v127, v126
    s_mov_b32 s52, s20
    s_mov_b32 s53, s21
    s_mov_b32 s54, 268435456
    s_mov_b32 s55, 0x20000
    s_mov_b32 s56, s38
    s_mov_b32 s57, s39
    s_mov_b32 s58, 1245184
    s_mov_b32 s59, 0x20000
    s_mul_i32 s67, s3, 32768
    s_mul_i32 s5, s8, 294912
    s_mul_i32 s6, s3, 9216
    s_add_u32 s5, s5, s6
    s_lshl_b32 s6, s9, 7
    s_add_u32 s5, s5, s6
    s_mov_b32 s46, 4718592
    s_mov_b32 s47, 0x20000
    s_cmp_ge_u32 s2, 208
    s_cselect_b32 s72, s72, s5
    s_cselect_b32 s73, s62, 36864
    s_cselect_b32 s74, s63, 36864
    s_cselect_b64 s[44:45], s[32:33], s[24:25]
    s_cselect_b32 s46, s42, s46
    v_lshrrev_b32 v68, 4, v0
    v_and_b32 v69, 15, v0
    v_add_u32 v10, s67, v1
    v_and_b32 v70, 3, v0
    v_lshlrev_b32 v70, 2, v70
    v_lshrrev_b32 v71, 2, v69
    v_or_b32 v70, v70, v71
    v_lshl_add_u32 v70, v70, 8, s67
    v_xor_b32 v71, v68, v69
    v_lshl_add_u32 v6, v71, 4, v70
    v_xor_b32 v7, 64, v6
    v_xor_b32 v8, 128, v6
    v_xor_b32 v9, 192, v6
    v_and_b32 v70, 1, v0
    v_cmp_eq_u32 vcc, 1, v70
    v_mov_b32 v71, 0x0c0c0100
    v_mov_b32 v72, 0x01000c0c
    v_cndmask_b32 v71, v71, v72, vcc
    v_mov_b32 v72, 0x0c0c0302
    v_mov_b32 v73, 0x03020c0c
    v_cndmask_b32 v72, v72, v73, vcc
    v_mov_b32 v73, 0x0c0c0c0c
    v_bfe_u32 v70, v0, 1, 2
    v_cmp_eq_u32 vcc, 0, v70
    s_nop 1
    v_cndmask_b32 v80, v73, v71, vcc
    v_cndmask_b32 v84, v73, v72, vcc
    v_cmp_eq_u32 vcc, 1, v70
    s_nop 1
    v_cndmask_b32 v81, v73, v71, vcc
    v_cndmask_b32 v85, v73, v72, vcc
    v_cmp_eq_u32 vcc, 2, v70
    s_nop 1
    v_cndmask_b32 v82, v73, v71, vcc
    v_cndmask_b32 v86, v73, v72, vcc
    v_cmp_eq_u32 vcc, 3, v70
    s_nop 1
    v_cndmask_b32 v83, v73, v71, vcc
    v_cndmask_b32 v87, v73, v72, vcc
    v_lshrrev_b32 v70, 3, v69
    v_lshlrev_b32 v70, 8, v70
    v_lshl_add_u32 v70, v68, 4, v70
    v_add_u32 v14, 140288, v70
    s_mov_b32 s68, 0xffff0000
    s_mov_b32 s69, 0x3db504f3
    s_mov_b32 s71, 0x3fb8aa3b
    v_mov_b32 v122, 0
    v_mov_b32 v120, 0xff800000
    v_mov_b32 v64, 0
    v_mov_b32 v65, 0
    v_mov_b32 v66, 0
    v_mov_b32 v67, 0
    s_waitcnt lgkmcnt(0)
    v_cmp_ne_u32 vcc, 0, v126
    s_waitcnt vmcnt(7)
    s_cbranch_vccnz L_w1
    s_waitcnt vmcnt(4)
L_w1:
    buffer_load_dwordx4 v[152:155], v4, s[48:51], s61 offen offset:2048 nt
    s_waitcnt vmcnt(7)
    s_cbranch_vccnz L_w2
    s_waitcnt vmcnt(4)
L_w2:
    buffer_load_dwordx4 v[156:159], v5, s[48:51], s61 offen offset:3072 nt
    s_xor_b32 s61, s60, 98304
    s_waitcnt vmcnt(7)
    s_cbranch_vccnz L_w3
    s_waitcnt vmcnt(4)
L_w3:
    buffer_load_dwordx4 v[160:163], v2, s[48:51], s61 offen offset:0 nt
    v_mov_b32 v124, 6
    ds_write_b32 v125, v124
    ds_read_b32 v126, v127
    s_waitcnt vmcnt(7)
    s_cbranch_vccnz L_w4
    s_waitcnt vmcnt(4)
L_w4:
    buffer_load_dwordx4 v[164:167], v3, s[48:51], s61 offen offset:1024 nt
    s_waitcnt lgkmcnt(0)
    v_cmp_ne_u32 vcc, 0, v126
    s_waitcnt vmcnt(7)
    s_cbranch_vccnz L_w5
    s_waitcnt vmcnt(4)
L_w5:
    buffer_load_dwordx4 v[168:171], v4, s[48:51], s61 offen offset:2048 nt
    s_waitcnt vmcnt(7)
    s_cbranch_vccnz L_w6
    s_waitcnt vmcnt(4)
L_w6:
    buffer_load_dwordx4 v[172:175], v5, s[48:51], s61 offen offset:3072 nt
    s_xor_b32 s61, s60, 122880
    s_waitcnt vmcnt(7)
    s_cbranch_vccnz L_w7
    s_waitcnt vmcnt(4)
L_w7:
    buffer_load_dwordx4 v[176:179], v2, s[48:51], s61 offen offset:0 nt
    v_mov_b32 v124, 7
    ds_write_b32 v125, v124
    ds_read_b32 v126, v127
    s_waitcnt vmcnt(7)
    s_cbranch_vccnz L_w8
    s_waitcnt vmcnt(4)
L_w8:
    buffer_load_dwordx4 v[180:183], v3, s[48:51], s61 offen offset:1024 nt
    s_waitcnt lgkmcnt(0)
    v_cmp_ne_u32 vcc, 0, v126
    s_waitcnt vmcnt(7)
    s_cbranch_vccnz L_w9
    s_waitcnt vmcnt(4)
L_w9:
    buffer_load_dwordx4 v[184:187], v4, s[48:51], s61 offen offset:2048 nt
    s_waitcnt vmcnt(7)
    s_cbranch_vccnz L_w10
    s_waitcnt vmcnt(4)
L_w10:
    buffer_load_dwordx4 v[188:191], v5, s[48:51], s61 offen offset:3072 nt
    s_xor_b32 s61, s60, 131072
    s_waitcnt vmcnt(7)
    s_cbranch_vccnz L_w11
    s_waitcnt vmcnt(4)
L_w11:
    buffer_load_dwordx4 v[192:195], v2, s[48:51], s61 offen offset:0 nt
    v_mov_b32 v124, 8
    ds_write_b32 v125, v124
    ds_read_b32 v126, v127
    s_waitcnt vmcnt(7)
    s_cbranch_vccnz L_w12
    s_waitcnt vmcnt(4)
L_w12:
    buffer_load_dwordx4 v[196:199], v3, s[48:51], s61 offen offset:1024 nt
    s_waitcnt lgkmcnt(0)
    v_cmp_ne_u32 vcc, 0, v126
    s_waitcnt vmcnt(7)
    s_cbranch_vccnz L_w13
    s_waitcnt vmcnt(4)
L_w13:
    buffer_load_dwordx4 v[200:203], v4, s[48:51], s61 offen offset:2048 nt
    s_waitcnt vmcnt(7)
    s_cbranch_vccnz L_w14
    s_waitcnt vmcnt(4)
L_w14:
    buffer_load_dwordx4 v[204:207], v5, s[48:51], s61 offen offset:3072 nt
    s_xor_b32 s61, s60, 155648
    s_waitcnt vmcnt(7)
    s_cbranch_vccnz L_w15
    s_waitcnt vmcnt(4)
L_w15:
    buffer_load_dwordx4 v[208:211], v2, s[48:51], s61 offen offset:0 nt
    v_mov_b32 v124, 9
    ds_write_b32 v125, v124
    ds_read_b32 v126, v127
    s_waitcnt vmcnt(7)
    s_cbranch_vccnz L_w16
    s_waitcnt vmcnt(4)
L_w16:
    buffer_load_dwordx4 v[212:215], v3, s[48:51], s61 offen offset:1024 nt
    s_waitcnt lgkmcnt(0)
    v_cmp_ne_u32 vcc, 0, v126
    s_waitcnt vmcnt(7)
    s_cbranch_vccnz L_w17
    s_waitcnt vmcnt(4)
L_w17:
    buffer_load_dwordx4 v[216:219], v4, s[48:51], s61 offen offset:2048 nt
    s_waitcnt vmcnt(7)
    s_cbranch_vccnz L_w18
    s_waitcnt vmcnt(4)
L_w18:
    buffer_load_dwordx4 v[220:223], v5, s[48:51], s61 offen offset:3072 nt
    s_xor_b32 s61, s60, 229376
    s_waitcnt vmcnt(7)
    s_cbranch_vccnz L_w19
    s_waitcnt vmcnt(4)
L_w19:
    buffer_load_dwordx4 v[224:227], v2, s[48:51], s61 offen offset:0 nt
    v_mov_b32 v124, 10
    ds_write_b32 v125, v124
    ds_read_b32 v126, v127
    s_waitcnt vmcnt(7)
    s_cbranch_vccnz L_w20
    s_waitcnt vmcnt(4)
L_w20:
    buffer_load_dwordx4 v[228:231], v3, s[48:51], s61 offen offset:1024 nt
    s_waitcnt lgkmcnt(0)
    v_cmp_ne_u32 vcc, 0, v126
    s_waitcnt vmcnt(7)
    s_cbranch_vccnz L_w21
    s_waitcnt vmcnt(4)
L_w21:
    buffer_load_dwordx4 v[232:235], v4, s[48:51], s61 offen offset:2048 nt
    s_waitcnt vmcnt(7)
    s_cbranch_vccnz L_w22
    s_waitcnt vmcnt(4)
L_w22:
    buffer_load_dwordx4 v[236:239], v5, s[48:51], s61 offen offset:3072 nt
    s_xor_b32 s61, s60, 253952
    s_waitcnt vmcnt(7)
    s_cbranch_vccnz L_w23
    s_waitcnt vmcnt(4)
L_w23:
    buffer_load_dwordx4 v[240:243], v2, s[48:51], s61 offen offset:0 nt
    v_mov_b32 v124, 11
    ds_write_b32 v125, v124
    ds_read_b32 v126, v127
    s_waitcnt vmcnt(7)
    s_cbranch_vccnz L_w24
    s_waitcnt vmcnt(4)
L_w24:
    buffer_load_dwordx4 v[244:247], v3, s[48:51], s61 offen offset:1024 nt
    s_waitcnt lgkmcnt(0)
    v_cmp_ne_u32 vcc, 0, v126
    s_waitcnt vmcnt(7)
    s_cbranch_vccnz L_w25
    s_waitcnt vmcnt(4)
L_w25:
    buffer_load_dwordx4 v[248:251], v4, s[48:51], s61 offen offset:2048 nt
    s_waitcnt vmcnt(7)
    s_cbranch_vccnz L_w26
    s_waitcnt vmcnt(4)
L_w26:
    buffer_load_dwordx4 v[252:255], v5, s[48:51], s61 offen offset:3072 nt
    v_mov_b32 v68, 145484
    s_mov_b32 s70, 16000000
L_spin27:
    ds_read_b32 v69, v68
    s_waitcnt lgkmcnt(0)
    v_readfirstlane_b32 s5, v69
    s_cmp_ge_u32 s5, 4
    s_cbranch_scc1 L_spin27_d
    s_sub_u32 s70, s70, 1
    s_cbranch_scc1 L_spin27_d
    s_sleep 2
    s_branch L_spin27
L_spin27_d:
    s_mov_b64 exec, -1
    s_xor_b32 s61, s60, 262144
    s_add_u32 m0, s67, 0
    s_waitcnt vmcnt(7)
    s_cbranch_vccnz L_w28
    s_waitcnt vmcnt(4)
L_w28:
    buffer_load_dwordx4 v2, s[48:51], s61 offen offset:0 nt lds
    v_mov_b32 v124, 12
    ds_write_b32 v125, v124
    ds_read_b32 v126, v127
    s_waitcnt vmcnt(7)
    s_cbranch_vccnz L_w29
    s_waitcnt vmcnt(4)
L_w29:
    buffer_load_dwordx4 v3, s[48:51], s61 offen offset:1024 nt lds
    s_waitcnt lgkmcnt(0)
    v_cmp_ne_u32 vcc, 0, v126
    s_waitcnt vmcnt(7)
    s_cbranch_vccnz L_w30
    s_waitcnt vmcnt(4)
L_w30:
    buffer_load_dwordx4 v4, s[48:51], s61 offen offset:2048 nt lds
    s_waitcnt vmcnt(7)
    s_cbranch_vccnz L_w31
    s_waitcnt vmcnt(4)
L_w31:
    buffer_load_dwordx4 v5, s[48:51], s61 offen offset:3072 nt lds
    s_xor_b32 s61, s60, 286720
    s_add_u32 m0, s67, 4096
    s_waitcnt vmcnt(7)
    s_cbranch_vccnz L_w32
    s_waitcnt vmcnt(4)
L_w32:
    buffer_load_dwordx4 v2, s[48:51], s61 offen offset:0 nt lds
    v_mov_b32 v124, 13
    ds_write_b32 v125, v124
    ds_read_b32 v126, v127
    s_waitcnt vmcnt(7)
    s_cbranch_vccnz L_w33
    s_waitcnt vmcnt(4)
L_w33:
    buffer_load_dwordx4 v3, s[48:51], s61 offen offset:1024 nt lds
    s_waitcnt lgkmcnt(0)
    v_cmp_ne_u32 vcc, 0, v126
    s_waitcnt vmcnt(7)
    s_cbranch_vccnz L_w34
    s_waitcnt vmcnt(4)
L_w34:
    buffer_load_dwordx4 v4, s[48:51], s61 offen offset:2048 nt lds
    s_waitcnt vmcnt(7)
    s_cbranch_vccnz L_w35
    s_waitcnt vmcnt(4)
L_w35:
    buffer_load_dwordx4 v5, s[48:51], s61 offen offset:3072 nt lds
    s_xor_b32 s61, s60, 360448
    s_add_u32 m0, s67, 8192
    s_waitcnt vmcnt(7)
    s_cbranch_vccnz L_w36
    s_waitcnt vmcnt(4)
L_w36:
    buffer_load_dwordx4 v2, s[48:51], s61 offen offset:0 nt lds
    v_mov_b32 v124, 14
    ds_write_b32 v125, v124
    ds_read_b32 v126, v127
    s_waitcnt vmcnt(7)
    s_cbranch_vccnz L_w37
    s_waitcnt vmcnt(4)
L_w37:
    buffer_load_dwordx4 v3, s[48:51], s61 offen offset:1024 nt lds
    s_waitcnt lgkmcnt(0)
    v_cmp_ne_u32 vcc, 0, v126
    s_waitcnt vmcnt(7)
    s_cbranch_vccnz L_w38
    s_waitcnt vmcnt(4)
L_w38:
    buffer_load_dwordx4 v4, s[48:51], s61 offen offset:2048 nt lds
    s_waitcnt vmcnt(7)
    s_cbranch_vccnz L_w39
    s_waitcnt vmcnt(4)
L_w39:
    buffer_load_dwordx4 v5, s[48:51], s61 offen offset:3072 nt lds
    s_xor_b32 s61, s60, 385024
    s_add_u32 m0, s67, 12288
    s_waitcnt vmcnt(7)
    s_cbranch_vccnz L_w40
    s_waitcnt vmcnt(4)
L_w40:
    buffer_load_dwordx4 v2, s[48:51], s61 offen offset:0 nt lds
    v_mov_b32 v124, 15
    ds_write_b32 v125, v124
    ds_read_b32 v126, v127
    s_waitcnt vmcnt(7)
    s_cbranch_vccnz L_w41
    s_waitcnt vmcnt(4)
L_w41:
    buffer_load_dwordx4 v3, s[48:51], s61 offen offset:1024 nt lds
    s_waitcnt lgkmcnt(0)
    v_cmp_ne_u32 vcc, 0, v126
    s_waitcnt vmcnt(7)
    s_cbranch_vccnz L_w42
    s_waitcnt vmcnt(4)
L_w42:
    buffer_load_dwordx4 v4, s[48:51], s61 offen offset:2048 nt lds
    s_waitcnt vmcnt(7)
    s_cbranch_vccnz L_w43
    s_waitcnt vmcnt(4)
L_w43:
    buffer_load_dwordx4 v5, s[48:51], s61 offen offset:3072 nt lds
    s_xor_b32 s61, s60, 393216
    s_add_u32 m0, s67, 16384
    s_waitcnt vmcnt(7)
    s_cbranch_vccnz L_w44
    s_waitcnt vmcnt(4)
L_w44:
    buffer_load_dwordx4 v2, s[48:51], s61 offen offset:0 nt lds
    v_mov_b32 v124, 16
    ds_write_b32 v125, v124
    ds_read_b32 v126, v127
    s_waitcnt vmcnt(7)
    s_cbranch_vccnz L_w45
    s_waitcnt vmcnt(4)
L_w45:
    buffer_load_dwordx4 v3, s[48:51], s61 offen offset:1024 nt lds
    s_waitcnt lgkmcnt(0)
    v_cmp_ne_u32 vcc, 0, v126
    s_waitcnt vmcnt(7)
    s_cbranch_vccnz L_w46
    s_waitcnt vmcnt(4)
L_w46:
    buffer_load_dwordx4 v4, s[48:51], s61 offen offset:2048 nt lds
    s_waitcnt vmcnt(7)
    s_cbranch_vccnz L_w47
    s_waitcnt vmcnt(4)
L_w47:
    buffer_load_dwordx4 v5, s[48:51], s61 offen offset:3072 nt lds
    s_xor_b32 s61, s60, 417792
    s_add_u32 m0, s67, 20480
    s_waitcnt vmcnt(7)
    s_cbranch_vccnz L_w48
    s_waitcnt vmcnt(4)
L_w48:
    buffer_load_dwordx4 v2, s[48:51], s61 offen offset:0 nt lds
    v_mov_b32 v124, 17
    ds_write_b32 v125, v124
    ds_read_b32 v126, v127
    s_waitcnt vmcnt(7)
    s_cbranch_vccnz L_w49
    s_waitcnt vmcnt(4)
L_w49:
    buffer_load_dwordx4 v3, s[48:51], s61 offen offset:1024 nt lds
    s_waitcnt lgkmcnt(0)
    v_cmp_ne_u32 vcc, 0, v126
    s_waitcnt vmcnt(7)
    s_cbranch_vccnz L_w50
    s_waitcnt vmcnt(4)
L_w50:
    buffer_load_dwordx4 v4, s[48:51], s61 offen offset:2048 nt lds
    s_waitcnt vmcnt(7)
    s_cbranch_vccnz L_w51
    s_waitcnt vmcnt(4)
L_w51:
    buffer_load_dwordx4 v5, s[48:51], s61 offen offset:3072 nt lds
    s_xor_b32 s61, s60, 491520
    s_add_u32 m0, s67, 24576
    s_waitcnt vmcnt(9)
    s_cbranch_vccnz L_w52
    s_waitcnt vmcnt(6)
L_w52:
    buffer_load_dwordx4 v2, s[48:51], s61 offen offset:0 nt lds
    v_mov_b32 v124, 18
    ds_write_b32 v125, v124
    ds_read_b32 v126, v127
    v_mov_b32 v68, 145476
    s_mov_b32 s70, 16000000
L_qw:
    ds_read_b32 v69, v68
    ds_read_b128 v[16:19], v14 offset:0
    ds_read_b128 v[20:23], v14 offset:64
    ds_read_b128 v[24:27], v14 offset:128
    ds_read_b128 v[28:31], v14 offset:192
    s_waitcnt lgkmcnt(0)
    v_readfirstlane_b32 s13, v69
    s_cmp_lg_u32 s13, 0
    s_cbranch_scc1 L_qd
    s_sub_u32 s70, s70, 1
    s_cbranch_scc1 L_qd
    s_sleep 2
    s_branch L_qw
L_qd:
    ds_read_b128 v[32:35], v6 offset:0
    ds_read_b128 v[36:39], v7 offset:0
    ds_read_b128 v[40:43], v8 offset:0
    ds_read_b128 v[44:47], v9 offset:0
    s_waitcnt vmcnt(9)
    s_cbranch_vccnz L_w53
    s_waitcnt vmcnt(6)
L_w53:
    buffer_load_dwordx4 v3, s[48:51], s61 offen offset:1024 nt lds
    s_waitcnt lgkmcnt(0)
    v_cmp_ne_u32 vcc, 0, v126
    s_waitcnt lgkmcnt(0)
    v_mfma_f32_16x16x32_bf16 v[76:79], v[32:35], v[16:19], 0
    v_mfma_f32_16x16x32_bf16 v[76:79], v[36:39], v[20:23], v[76:79]
    v_mfma_f32_16x16x32_bf16 v[76:79], v[40:43], v[24:27], v[76:79]
    v_mfma_f32_16x16x32_bf16 v[76:79], v[44:47], v[28:31], v[76:79]
    s_waitcnt vmcnt(9)
    s_cbranch_vccnz L_w54
    s_waitcnt vmcnt(6)
L_w54:
    buffer_load_dwordx4 v4, s[48:51], s61 offen offset:2048 nt lds
    s_nop 4
    v_cvt_pk_bf16_f32 v68, v76, v77
    v_cvt_pk_bf16_f32 v69, v78, v79
    v_lshlrev_b32 v70, 16, v68
    v_and_b32 v71, s68, v68
    v_lshlrev_b32 v72, 16, v69
    v_and_b32 v73, s68, v69
    v_mul_f32 v70, s69, v70
    v_mul_f32 v71, s69, v71
    v_mul_f32 v72, s69, v72
    v_mul_f32 v73, s69, v73
    v_cvt_pk_bf16_f32 v104, v70, v71
    v_cvt_pk_bf16_f32 v105, v72, v73
    v_lshlrev_b32 v70, 16, v104
    v_and_b32 v71, s68, v104
    v_lshlrev_b32 v72, 16, v105
    v_and_b32 v73, s68, v105
    v_max3_f32 v120, v120, v70, v71
    v_max3_f32 v120, v120, v72, v73
    ds_write_b128 v10, v[128:131] offset:0
    ds_write_b128 v10, v[132:135] offset:1024
    ds_write_b128 v10, v[136:139] offset:2048
    ds_write_b128 v10, v[140:143] offset:3072
    ds_read_b128 v[32:35], v6 offset:0
    ds_read_b128 v[36:39], v7 offset:0
    ds_read_b128 v[40:43], v8 offset:0
    ds_read_b128 v[44:47], v9 offset:0
    s_waitcnt vmcnt(9)
    s_cbranch_vccnz L_w55
    s_waitcnt vmcnt(6)
L_w55:
    buffer_load_dwordx4 v5, s[48:51], s61 offen offset:3072 nt lds
    s_waitcnt lgkmcnt(0)
    v_mfma_f32_16x16x32_bf16 v[76:79], v[32:35], v[16:19], 0
    v_mfma_f32_16x16x32_bf16 v[76:79], v[36:39], v[20:23], v[76:79]
    v_mfma_f32_16x16x32_bf16 v[76:79], v[40:43], v[24:27], v[76:79]
    v_mfma_f32_16x16x32_bf16 v[76:79], v[44:47], v[28:31], v[76:79]
    s_xor_b32 s61, s60, 516096
    s_add_u32 m0, s67, 28672
    s_waitcnt vmcnt(9)
    s_cbranch_vccnz L_w56
    s_waitcnt vmcnt(6)
L_w56:
    buffer_load_dwordx4 v2, s[48:51], s61 offen offset:0 nt lds
    v_mov_b32 v124, 19
    ds_write_b32 v125, v124
    ds_read_b32 v126, v127
    v_cvt_pk_bf16_f32 v68, v76, v77
    v_cvt_pk_bf16_f32 v69, v78, v79
    v_lshlrev_b32 v70, 16, v68
    v_and_b32 v71, s68, v68
    v_lshlrev_b32 v72, 16, v69
    v_and_b32 v73, s68, v69
    v_mul_f32 v70, s69, v70
    v_mul_f32 v71, s69, v71
    v_mul_f32 v72, s69, v72
    v_mul_f32 v73, s69, v73
    v_cvt_pk_bf16_f32 v88, v70, v71
    v_cvt_pk_bf16_f32 v89, v72, v73
    v_lshlrev_b32 v70, 16, v88
    v_and_b32 v71, s68, v88
    v_lshlrev_b32 v72, 16, v89
    v_and_b32 v73, s68, v89
    v_max3_f32 v120, v120, v70, v71
    v_max3_f32 v120, v120, v72, v73
    ds_read_b128 v[32:35], v6 offset:4096
    ds_read_b128 v[36:39], v7 offset:4096
    ds_read_b128 v[40:43], v8 offset:4096
    ds_read_b128 v[44:47], v9 offset:4096
    s_waitcnt vmcnt(9)
    s_cbranch_vccnz L_w57
    s_waitcnt vmcnt(6)
L_w57:
    buffer_load_dwordx4 v3, s[48:51], s61 offen offset:1024 nt lds
    s_waitcnt lgkmcnt(0)
    v_cmp_ne_u32 vcc, 0, v126
    s_waitcnt lgkmcnt(0)
    v_mfma_f32_16x16x32_bf16 v[76:79], v[32:35], v[16:19], 0
    v_mfma_f32_16x16x32_bf16 v[76:79], v[36:39], v[20:23], v[76:79]
    v_mfma_f32_16x16x32_bf16 v[76:79], v[40:43], v[24:27], v[76:79]
    v_mfma_f32_16x16x32_bf16 v[76:79], v[44:47], v[28:31], v[76:79]
    s_waitcnt vmcnt(9)
    s_cbranch_vccnz L_w58
    s_waitcnt vmcnt(6)
L_w58:
    buffer_load_dwordx4 v4, s[48:51], s61 offen offset:2048 nt lds
    s_nop 4
    v_cvt_pk_bf16_f32 v68, v76, v77
    v_cvt_pk_bf16_f32 v69, v78, v79
    v_lshlrev_b32 v70, 16, v68
    v_and_b32 v71, s68, v68
    v_lshlrev_b32 v72, 16, v69
    v_and_b32 v73, s68, v69
    v_mul_f32 v70, s69, v70
    v_mul_f32 v71, s69, v71
    v_mul_f32 v72, s69, v72
    v_mul_f32 v73, s69, v73
    v_cvt_pk_bf16_f32 v106, v70, v71
    v_cvt_pk_bf16_f32 v107, v72, v73
    v_lshlrev_b32 v70, 16, v106
    v_and_b32 v71, s68, v106
    v_lshlrev_b32 v72, 16, v107
    v_and_b32 v73, s68, v107
    v_max3_f32 v120, v120, v70, v71
    v_max3_f32 v120, v120, v72, v73
    ds_write_b128 v10, v[144:147] offset:0
    ds_write_b128 v10, v[148:151] offset:1024
    ds_write_b128 v10, v[152:155] offset:2048
    ds_write_b128 v10, v[156:159] offset:3072
    ds_read_b128 v[32:35], v6 offset:0
    ds_read_b128 v[36:39], v7 offset:0
    ds_read_b128 v[40:43], v8 offset:0
    ds_read_b128 v[44:47], v9 offset:0
    s_waitcnt vmcnt(9)
    s_cbranch_vccnz L_w59
    s_waitcnt vmcnt(6)
L_w59:
    buffer_load_dwordx4 v5, s[48:51], s61 offen offset:3072 nt lds
    s_waitcnt lgkmcnt(0)
    v_mfma_f32_16x16x32_bf16 v[76:79], v[32:35], v[16:19], 0
    v_mfma_f32_16x16x32_bf16 v[76:79], v[36:39], v[20:23], v[76:79]
    v_mfma_f32_16x16x32_bf16 v[76:79], v[40:43], v[24:27], v[76:79]
    v_mfma_f32_16x16x32_bf16 v[76:79], v[44:47], v[28:31], v[76:79]
    s_xor_b32 s61, s60, 0
    s_waitcnt vmcnt(7)
    s_cbranch_vccnz L_w60
    s_waitcnt vmcnt(4)
L_w60:
    buffer_load_dwordx4 v[128:131], v1, s[52:55], s61 offen offset:0 nt
    v_mov_b32 v124, 20
    ds_write_b32 v125, v124
    ds_read_b32 v126, v127
    s_nop 0
    v_cvt_pk_bf16_f32 v68, v76, v77
    v_cvt_pk_bf16_f32 v69, v78, v79
    v_lshlrev_b32 v70, 16, v68
    v_and_b32 v71, s68, v68
    v_lshlrev_b32 v72, 16, v69
    v_and_b32 v73, s68, v69
    v_mul_f32 v70, s69, v70
    v_mul_f32 v71, s69, v71
    v_mul_f32 v72, s69, v72
    v_mul_f32 v73, s69, v73
    v_cvt_pk_bf16_f32 v90, v70, v71
    v_cvt_pk_bf16_f32 v91, v72, v73
    v_lshlrev_b32 v70, 16, v90
    v_and_b32 v71, s68, v90
    v_lshlrev_b32 v72, 16, v91
    v_and_b32 v73, s68, v91
    v_max3_f32 v120, v120, v70, v71
    v_max3_f32 v120, v120, v72, v73
    ds_read_b128 v[32:35], v6 offset:8192
    ds_read_b128 v[36:39], v7 offset:8192
    ds_read_b128 v[40:43], v8 offset:8192
    ds_read_b128 v[44:47], v9 offset:8192
    s_waitcnt vmcnt(7)
    s_cbranch_vccnz L_w61
    s_waitcnt vmcnt(4)
L_w61:
    buffer_load_dwordx4 v[132:135], v1, s[52:55], s61 offen offset:1024 nt
    s_waitcnt lgkmcnt(0)
    v_cmp_ne_u32 vcc, 0, v126
    s_waitcnt lgkmcnt(0)
    v_mfma_f32_16x16x32_bf16 v[76:79], v[32:35], v[16:19], 0
    v_mfma_f32_16x16x32_bf16 v[76:79], v[36:39], v[20:23], v[76:79]
    v_mfma_f32_16x16x32_bf16 v[76:79], v[40:43], v[24:27], v[76:79]
    v_mfma_f32_16x16x32_bf16 v[76:79], v[44:47], v[28:31], v[76:79]
    s_waitcnt vmcnt(7)
    s_cbranch_vccnz L_w62
    s_waitcnt vmcnt(4)
L_w62:
    buffer_load_dwordx4 v[136:139], v1, s[52:55], s61 offen offset:2048 nt
    s_nop 4
    v_cvt_pk_bf16_f32 v68, v76, v77
    v_cvt_pk_bf16_f32 v69, v78, v79
    v_lshlrev_b32 v70, 16, v68
    v_and_b32 v71, s68, v68
    v_lshlrev_b32 v72, 16, v69
    v_and_b32 v73, s68, v69
    v_mul_f32 v70, s69, v70
    v_mul_f32 v71, s69, v71
    v_mul_f32 v72, s69, v72
    v_mul_f32 v73, s69, v73
    v_cvt_pk_bf16_f32 v108, v70, v71
    v_cvt_pk_bf16_f32 v109, v72, v73
    v_lshlrev_b32 v70, 16, v108
    v_and_b32 v71, s68, v108
    v_lshlrev_b32 v72, 16, v109
    v_and_b32 v73, s68, v109
    v_max3_f32 v120, v120, v70, v71
    v_max3_f32 v120, v120, v72, v73
    ds_write_b128 v10, v[160:163] offset:0
    ds_write_b128 v10, v[164:167] offset:1024
    ds_write_b128 v10, v[168:171] offset:2048
    ds_write_b128 v10, v[172:175] offset:3072
    ds_read_b128 v[32:35], v6 offset:0
    ds_read_b128 v[36:39], v7 offset:0
    ds_read_b128 v[40:43], v8 offset:0
    ds_read_b128 v[44:47], v9 offset:0
    s_waitcnt vmcnt(7)
    s_cbranch_vccnz L_w63
    s_waitcnt vmcnt(4)
L_w63:
    buffer_load_dwordx4 v[140:143], v1, s[52:55], s61 offen offset:3072 nt
    s_waitcnt lgkmcnt(0)
    v_mfma_f32_16x16x32_bf16 v[76:79], v[32:35], v[16:19], 0
    v_mfma_f32_16x16x32_bf16 v[76:79], v[36:39], v[20:23], v[76:79]
    v_mfma_f32_16x16x32_bf16 v[76:79], v[40:43], v[24:27], v[76:79]
    v_mfma_f32_16x16x32_bf16 v[76:79], v[44:47], v[28:31], v[76:79]
    s_xor_b32 s61, s60, 24576
    s_waitcnt vmcnt(7)
    s_cbranch_vccnz L_w64
    s_waitcnt vmcnt(4)
L_w64:
    buffer_load_dwordx4 v[144:147], v1, s[52:55], s61 offen offset:0 nt
    v_mov_b32 v124, 21
    ds_write_b32 v125, v124
    ds_read_b32 v126, v127
    s_nop 0
    v_cvt_pk_bf16_f32 v68, v76, v77
    v_cvt_pk_bf16_f32 v69, v78, v79
    v_lshlrev_b32 v70, 16, v68
    v_and_b32 v71, s68, v68
    v_lshlrev_b32 v72, 16, v69
    v_and_b32 v73, s68, v69
    v_mul_f32 v70, s69, v70
    v_mul_f32 v71, s69, v71
    v_mul_f32 v72, s69, v72
    v_mul_f32 v73, s69, v73
    v_cvt_pk_bf16_f32 v92, v70, v71
    v_cvt_pk_bf16_f32 v93, v72, v73
    v_lshlrev_b32 v70, 16, v92
    v_and_b32 v71, s68, v92
    v_lshlrev_b32 v72, 16, v93
    v_and_b32 v73, s68, v93
    v_max3_f32 v120, v120, v70, v71
    v_max3_f32 v120, v120, v72, v73
    ds_read_b128 v[32:35], v6 offset:12288
    ds_read_b128 v[36:39], v7 offset:12288
    ds_read_b128 v[40:43], v8 offset:12288
    ds_read_b128 v[44:47], v9 offset:12288
    s_waitcnt vmcnt(7)
    s_cbranch_vccnz L_w65
    s_waitcnt vmcnt(4)
L_w65:
    buffer_load_dwordx4 v[148:151], v1, s[52:55], s61 offen offset:1024 nt
    s_waitcnt lgkmcnt(0)
    v_cmp_ne_u32 vcc, 0, v126
    s_waitcnt lgkmcnt(0)
    v_mfma_f32_16x16x32_bf16 v[76:79], v[32:35], v[16:19], 0
    v_mfma_f32_16x16x32_bf16 v[76:79], v[36:39], v[20:23], v[76:79]
    v_mfma_f32_16x16x32_bf16 v[76:79], v[40:43], v[24:27], v[76:79]
    v_mfma_f32_16x16x32_bf16 v[76:79], v[44:47], v[28:31], v[76:79]
    s_waitcnt vmcnt(7)
    s_cbranch_vccnz L_w66
    s_waitcnt vmcnt(4)
L_w66:
    buffer_load_dwordx4 v[152:155], v1, s[52:55], s61 offen offset:2048 nt
    s_nop 4
    v_cvt_pk_bf16_f32 v68, v76, v77
    v_cvt_pk_bf16_f32 v69, v78, v79
    v_lshlrev_b32 v70, 16, v68
    v_and_b32 v71, s68, v68
    v_lshlrev_b32 v72, 16, v69
    v_and_b32 v73, s68, v69
    v_mul_f32 v70, s69, v70
    v_mul_f32 v71, s69, v71
    v_mul_f32 v72, s69, v72
    v_mul_f32 v73, s69, v73
    v_cvt_pk_bf16_f32 v110, v70, v71
    v_cvt_pk_bf16_f32 v111, v72, v73
    v_lshlrev_b32 v70, 16, v110
    v_and_b32 v71, s68, v110
    v_lshlrev_b32 v72, 16, v111
    v_and_b32 v73, s68, v111
    v_max3_f32 v120, v120, v70, v71
    v_max3_f32 v120, v120, v72, v73
    ds_write_b128 v10, v[176:179] offset:0
    ds_write_b128 v10, v[180:183] offset:1024
    ds_write_b128 v10, v[184:187] offset:2048
    ds_write_b128 v10, v[188:191] offset:3072
    ds_read_b128 v[32:35], v6 offset:0
    ds_read_b128 v[36:39], v7 offset:0
    ds_read_b128 v[40:43], v8 offset:0
    ds_read_b128 v[44:47], v9 offset:0
    s_waitcnt vmcnt(7)
    s_cbranch_vccnz L_w67
    s_waitcnt vmcnt(4)
L_w67:
    buffer_load_dwordx4 v[156:159], v1, s[52:55], s61 offen offset:3072 nt
    s_waitcnt lgkmcnt(0)
    v_mfma_f32_16x16x32_bf16 v[76:79], v[32:35], v[16:19], 0
    v_mfma_f32_16x16x32_bf16 v[76:79], v[36:39], v[20:23], v[76:79]
    v_mfma_f32_16x16x32_bf16 v[76:79], v[40:43], v[24:27], v[76:79]
    v_mfma_f32_16x16x32_bf16 v[76:79], v[44:47], v[28:31], v[76:79]
    s_xor_b32 s61, s60, 98304
    s_waitcnt vmcnt(7)
    s_cbranch_vccnz L_w68
    s_waitcnt vmcnt(4)
L_w68:
    buffer_load_dwordx4 v[160:163], v1, s[52:55], s61 offen offset:0 nt
    v_mov_b32 v124, 22
    ds_write_b32 v125, v124
    ds_read_b32 v126, v127
    s_nop 0
    v_cvt_pk_bf16_f32 v68, v76, v77
    v_cvt_pk_bf16_f32 v69, v78, v79
    v_lshlrev_b32 v70, 16, v68
    v_and_b32 v71, s68, v68
    v_lshlrev_b32 v72, 16, v69
    v_and_b32 v73, s68, v69
    v_mul_f32 v70, s69, v70
    v_mul_f32 v71, s69, v71
    v_mul_f32 v72, s69, v72
    v_mul_f32 v73, s69, v73
    v_cvt_pk_bf16_f32 v94, v70, v71
    v_cvt_pk_bf16_f32 v95, v72, v73
    v_lshlrev_b32 v70, 16, v94
    v_and_b32 v71, s68, v94
    v_lshlrev_b32 v72, 16, v95
    v_and_b32 v73, s68, v95
    v_max3_f32 v120, v120, v70, v71
    v_max3_f32 v120, v120, v72, v73
    ds_read_b128 v[32:35], v6 offset:16384
    ds_read_b128 v[36:39], v7 offset:16384
    ds_read_b128 v[40:43], v8 offset:16384
    ds_read_b128 v[44:47], v9 offset:16384
    s_waitcnt vmcnt(7)
    s_cbranch_vccnz L_w69
    s_waitcnt vmcnt(4)
L_w69:
    buffer_load_dwordx4 v[164:167], v1, s[52:55], s61 offen offset:1024 nt
    s_waitcnt lgkmcnt(0)
    v_cmp_ne_u32 vcc, 0, v126
    s_waitcnt lgkmcnt(0)
    v_mfma_f32_16x16x32_bf16 v[76:79], v[32:35], v[16:19], 0
    v_mfma_f32_16x16x32_bf16 v[76:79], v[36:39], v[20:23], v[76:79]
    v_mfma_f32_16x16x32_bf16 v[76:79], v[40:43], v[24:27], v[76:79]
    v_mfma_f32_16x16x32_bf16 v[76:79], v[44:47], v[28:31], v[76:79]
    s_waitcnt vmcnt(7)
    s_cbranch_vccnz L_w70
    s_waitcnt vmcnt(4)
L_w70:
    buffer_load_dwordx4 v[168:171], v1, s[52:55], s61 offen offset:2048 nt
    s_nop 4
    v_cvt_pk_bf16_f32 v68, v76, v77
    v_cvt_pk_bf16_f32 v69, v78, v79
    v_lshlrev_b32 v70, 16, v68
    v_and_b32 v71, s68, v68
    v_lshlrev_b32 v72, 16, v69
    v_and_b32 v73, s68, v69
    v_mul_f32 v70, s69, v70
    v_mul_f32 v71, s69, v71
    v_mul_f32 v72, s69, v72
    v_mul_f32 v73, s69, v73
    v_cvt_pk_bf16_f32 v112, v70, v71
    v_cvt_pk_bf16_f32 v113, v72, v73
    v_lshlrev_b32 v70, 16, v112
    v_and_b32 v71, s68, v112
    v_lshlrev_b32 v72, 16, v113
    v_and_b32 v73, s68, v113
    v_max3_f32 v120, v120, v70, v71
    v_max3_f32 v120, v120, v72, v73
    ds_write_b128 v10, v[192:195] offset:0
    ds_write_b128 v10, v[196:199] offset:1024
    ds_write_b128 v10, v[200:203] offset:2048
    ds_write_b128 v10, v[204:207] offset:3072
    ds_read_b128 v[32:35], v6 offset:0
    ds_read_b128 v[36:39], v7 offset:0
    ds_read_b128 v[40:43], v8 offset:0
    ds_read_b128 v[44:47], v9 offset:0
    s_waitcnt vmcnt(7)
    s_cbranch_vccnz L_w71
    s_waitcnt vmcnt(4)
L_w71:
    buffer_load_dwordx4 v[172:175], v1, s[52:55], s61 offen offset:3072 nt
    s_waitcnt lgkmcnt(0)
    v_mfma_f32_16x16x32_bf16 v[76:79], v[32:35], v[16:19], 0
    v_mfma_f32_16x16x32_bf16 v[76:79], v[36:39], v[20:23], v[76:79]
    v_mfma_f32_16x16x32_bf16 v[76:79], v[40:43], v[24:27], v[76:79]
    v_mfma_f32_16x16x32_bf16 v[76:79], v[44:47], v[28:31], v[76:79]
    s_xor_b32 s61, s60, 122880
    s_waitcnt vmcnt(7)
    s_cbranch_vccnz L_w72
    s_waitcnt vmcnt(4)
L_w72:
    buffer_load_dwordx4 v[176:179], v1, s[52:55], s61 offen offset:0 nt
    v_mov_b32 v124, 23
    ds_write_b32 v125, v124
    ds_read_b32 v126, v127
    s_nop 0
    v_cvt_pk_bf16_f32 v68, v76, v77
    v_cvt_pk_bf16_f32 v69, v78, v79
    v_lshlrev_b32 v70, 16, v68
    v_and_b32 v71, s68, v68
    v_lshlrev_b32 v72, 16, v69
    v_and_b32 v73, s68, v69
    v_mul_f32 v70, s69, v70
    v_mul_f32 v71, s69, v71
    v_mul_f32 v72, s69, v72
    v_mul_f32 v73, s69, v73
    v_cvt_pk_bf16_f32 v96, v70, v71
    v_cvt_pk_bf16_f32 v97, v72, v73
    v_lshlrev_b32 v70, 16, v96
    v_and_b32 v71, s68, v96
    v_lshlrev_b32 v72, 16, v97
    v_and_b32 v73, s68, v97
    v_max3_f32 v120, v120, v70, v71
    v_max3_f32 v120, v120, v72, v73
    ds_read_b128 v[32:35], v6 offset:20480
    ds_read_b128 v[36:39], v7 offset:20480
    ds_read_b128 v[40:43], v8 offset:20480
    ds_read_b128 v[44:47], v9 offset:20480
    s_waitcnt vmcnt(7)
    s_cbranch_vccnz L_w73
    s_waitcnt vmcnt(4)
L_w73:
    buffer_load_dwordx4 v[180:183], v1, s[52:55], s61 offen offset:1024 nt
    s_waitcnt lgkmcnt(0)
    v_cmp_ne_u32 vcc, 0, v126
    s_waitcnt lgkmcnt(0)
    v_mfma_f32_16x16x32_bf16 v[76:79], v[32:35], v[16:19], 0
    v_mfma_f32_16x16x32_bf16 v[76:79], v[36:39], v[20:23], v[76:79]
    v_mfma_f32_16x16x32_bf16 v[76:79], v[40:43], v[24:27], v[76:79]
    v_mfma_f32_16x16x32_bf16 v[76:79], v[44:47], v[28:31], v[76:79]
    s_waitcnt vmcnt(7)
    s_cbranch_vccnz L_w74
    s_waitcnt vmcnt(4)
L_w74:
    buffer_load_dwordx4 v[184:187], v1, s[52:55], s61 offen offset:2048 nt
    s_nop 4
    v_cvt_pk_bf16_f32 v68, v76, v77
    v_cvt_pk_bf16_f32 v69, v78, v79
    v_lshlrev_b32 v70, 16, v68
    v_and_b32 v71, s68, v68
    v_lshlrev_b32 v72, 16, v69
    v_and_b32 v73, s68, v69
    v_mul_f32 v70, s69, v70
    v_mul_f32 v71, s69, v71
    v_mul_f32 v72, s69, v72
    v_mul_f32 v73, s69, v73
    v_cvt_pk_bf16_f32 v114, v70, v71
    v_cvt_pk_bf16_f32 v115, v72, v73
    v_lshlrev_b32 v70, 16, v114
    v_and_b32 v71, s68, v114
    v_lshlrev_b32 v72, 16, v115
    v_and_b32 v73, s68, v115
    v_max3_f32 v120, v120, v70, v71
    v_max3_f32 v120, v120, v72, v73
    ds_write_b128 v10, v[208:211] offset:0
    ds_write_b128 v10, v[212:215] offset:1024
    ds_write_b128 v10, v[216:219] offset:2048
    ds_write_b128 v10, v[220:223] offset:3072
    ds_read_b128 v[32:35], v6 offset:0
    ds_read_b128 v[36:39], v7 offset:0
    ds_read_b128 v[40:43], v8 offset:0
    ds_read_b128 v[44:47], v9 offset:0
    s_waitcnt vmcnt(7)
    s_cbranch_vccnz L_w75
    s_waitcnt vmcnt(4)
L_w75:
    buffer_load_dwordx4 v[188:191], v1, s[52:55], s61 offen offset:3072 nt
    s_waitcnt lgkmcnt(0)
    v_mfma_f32_16x16x32_bf16 v[76:79], v[32:35], v[16:19], 0
    v_mfma_f32_16x16x32_bf16 v[76:79], v[36:39], v[20:23], v[76:79]
    v_mfma_f32_16x16x32_bf16 v[76:79], v[40:43], v[24:27], v[76:79]
    v_mfma_f32_16x16x32_bf16 v[76:79], v[44:47], v[28:31], v[76:79]
    s_xor_b32 s61, s60, 131072
    s_waitcnt vmcnt(7)
    s_cbranch_vccnz L_w76
    s_waitcnt vmcnt(4)
L_w76:
    buffer_load_dwordx4 v[192:195], v1, s[52:55], s61 offen offset:0 nt
    v_mov_b32 v124, 24
    ds_write_b32 v125, v124
    ds_read_b32 v126, v127
    s_nop 0
    v_cvt_pk_bf16_f32 v68, v76, v77
    v_cvt_pk_bf16_f32 v69, v78, v79
    v_lshlrev_b32 v70, 16, v68
    v_and_b32 v71, s68, v68
    v_lshlrev_b32 v72, 16, v69
    v_and_b32 v73, s68, v69
    v_mul_f32 v70, s69, v70
    v_mul_f32 v71, s69, v71
    v_mul_f32 v72, s69, v72
    v_mul_f32 v73, s69, v73
    v_cvt_pk_bf16_f32 v98, v70, v71
    v_cvt_pk_bf16_f32 v99, v72, v73
    v_lshlrev_b32 v70, 16, v98
    v_and_b32 v71, s68, v98
    v_lshlrev_b32 v72, 16, v99
    v_and_b32 v73, s68, v99
    v_max3_f32 v120, v120, v70, v71
    v_max3_f32 v120, v120, v72, v73
    ds_read_b128 v[32:35], v6 offset:24576
    ds_read_b128 v[36:39], v7 offset:24576
    ds_read_b128 v[40:43], v8 offset:24576
    ds_read_b128 v[44:47], v9 offset:24576
    s_waitcnt vmcnt(7)
    s_cbranch_vccnz L_w77
    s_waitcnt vmcnt(4)
L_w77:
    buffer_load_dwordx4 v[196:199], v1, s[52:55], s61 offen offset:1024 nt
    s_waitcnt lgkmcnt(0)
    v_cmp_ne_u32 vcc, 0, v126
    s_waitcnt lgkmcnt(0)
    v_mfma_f32_16x16x32_bf16 v[76:79], v[32:35], v[16:19], 0
    v_mfma_f32_16x16x32_bf16 v[76:79], v[36:39], v[20:23], v[76:79]
    v_mfma_f32_16x16x32_bf16 v[76:79], v[40:43], v[24:27], v[76:79]
    v_mfma_f32_16x16x32_bf16 v[76:79], v[44:47], v[28:31], v[76:79]
    s_waitcnt vmcnt(7)
    s_cbranch_vccnz L_w78
    s_waitcnt vmcnt(4)
L_w78:
    buffer_load_dwordx4 v[200:203], v1, s[52:55], s61 offen offset:2048 nt
    s_nop 4
    v_cvt_pk_bf16_f32 v68, v76, v77
    v_cvt_pk_bf16_f32 v69, v78, v79
    v_lshlrev_b32 v70, 16, v68
    v_and_b32 v71, s68, v68
    v_lshlrev_b32 v72, 16, v69
    v_and_b32 v73, s68, v69
    v_mul_f32 v70, s69, v70
    v_mul_f32 v71, s69, v71
    v_mul_f32 v72, s69, v72
    v_mul_f32 v73, s69, v73
    v_cvt_pk_bf16_f32 v116, v70, v71
    v_cvt_pk_bf16_f32 v117, v72, v73
    v_lshlrev_b32 v70, 16, v116
    v_and_b32 v71, s68, v116
    v_lshlrev_b32 v72, 16, v117
    v_and_b32 v73, s68, v117
    v_max3_f32 v120, v120, v70, v71
    v_max3_f32 v120, v120, v72, v73
    ds_write_b128 v10, v[224:227] offset:0
    ds_write_b128 v10, v[228:231] offset:1024
    ds_write_b128 v10, v[232:235] offset:2048
    ds_write_b128 v10, v[236:239] offset:3072
    ds_read_b128 v[32:35], v6 offset:0
    ds_read_b128 v[36:39], v7 offset:0
    ds_read_b128 v[40:43], v8 offset:0
    ds_read_b128 v[44:47], v9 offset:0
    s_waitcnt vmcnt(7)
    s_cbranch_vccnz L_w79
    s_waitcnt vmcnt(4)
L_w79:
    buffer_load_dwordx4 v[204:207], v1, s[52:55], s61 offen offset:3072 nt
    s_waitcnt lgkmcnt(0)
    v_mfma_f32_16x16x32_bf16 v[76:79], v[32:35], v[16:19], 0
    v_mfma_f32_16x16x32_bf16 v[76:79], v[36:39], v[20:23], v[76:79]
    v_mfma_f32_16x16x32_bf16 v[76:79], v[40:43], v[24:27], v[76:79]
    v_mfma_f32_16x16x32_bf16 v[76:79], v[44:47], v[28:31], v[76:79]
    s_xor_b32 s61, s60, 155648
    s_waitcnt vmcnt(7)
    s_cbranch_vccnz L_w80
    s_waitcnt vmcnt(4)
L_w80:
    buffer_load_dwordx4 v[208:211], v1, s[52:55], s61 offen offset:0 nt
    v_mov_b32 v124, 25
    ds_write_b32 v125, v124
    ds_read_b32 v126, v127
    s_nop 0
    v_cvt_pk_bf16_f32 v68, v76, v77
    v_cvt_pk_bf16_f32 v69, v78, v79
    v_lshlrev_b32 v70, 16, v68
    v_and_b32 v71, s68, v68
    v_lshlrev_b32 v72, 16, v69
    v_and_b32 v73, s68, v69
    v_mul_f32 v70, s69, v70
    v_mul_f32 v71, s69, v71
    v_mul_f32 v72, s69, v72
    v_mul_f32 v73, s69, v73
    v_cvt_pk_bf16_f32 v100, v70, v71
    v_cvt_pk_bf16_f32 v101, v72, v73
    v_lshlrev_b32 v70, 16, v100
    v_and_b32 v71, s68, v100
    v_lshlrev_b32 v72, 16, v101
    v_and_b32 v73, s68, v101
    v_max3_f32 v120, v120, v70, v71
    v_max3_f32 v120, v120, v72, v73
    ds_read_b128 v[32:35], v6 offset:28672
    ds_read_b128 v[36:39], v7 offset:28672
    ds_read_b128 v[40:43], v8 offset:28672
    ds_read_b128 v[44:47], v9 offset:28672
    s_waitcnt vmcnt(7)
    s_cbranch_vccnz L_w81
    s_waitcnt vmcnt(4)
L_w81:
    buffer_load_dwordx4 v[212:215], v1, s[52:55], s61 offen offset:1024 nt
    s_waitcnt lgkmcnt(0)
    v_cmp_ne_u32 vcc, 0, v126
    s_waitcnt lgkmcnt(0)
    v_mfma_f32_16x16x32_bf16 v[76:79], v[32:35], v[16:19], 0
    v_mfma_f32_16x16x32_bf16 v[76:79], v[36:39], v[20:23], v[76:79]
    v_mfma_f32_16x16x32_bf16 v[76:79], v[40:43], v[24:27], v[76:79]
    v_mfma_f32_16x16x32_bf16 v[76:79], v[44:47], v[28:31], v[76:79]
    s_waitcnt vmcnt(7)
    s_cbranch_vccnz L_w82
    s_waitcnt vmcnt(4)
L_w82:
    buffer_load_dwordx4 v[216:219], v1, s[52:55], s61 offen offset:2048 nt
    s_nop 4
    v_cvt_pk_bf16_f32 v68, v76, v77
    v_cvt_pk_bf16_f32 v69, v78, v79
    v_lshlrev_b32 v70, 16, v68
    v_and_b32 v71, s68, v68
    v_lshlrev_b32 v72, 16, v69
    v_and_b32 v73, s68, v69
    v_mul_f32 v70, s69, v70
    v_mul_f32 v71, s69, v71
    v_mul_f32 v72, s69, v72
    v_mul_f32 v73, s69, v73
    v_cvt_pk_bf16_f32 v118, v70, v71
    v_cvt_pk_bf16_f32 v119, v72, v73
    v_lshlrev_b32 v70, 16, v118
    v_and_b32 v71, s68, v118
    v_lshlrev_b32 v72, 16, v119
    v_and_b32 v73, s68, v119
    v_max3_f32 v120, v120, v70, v71
    v_max3_f32 v120, v120, v72, v73
    ds_write_b128 v10, v[240:243] offset:0
    ds_write_b128 v10, v[244:247] offset:1024
    ds_write_b128 v10, v[248:251] offset:2048
    ds_write_b128 v10, v[252:255] offset:3072
    ds_read_b128 v[32:35], v6 offset:0
    ds_read_b128 v[36:39], v7 offset:0
    ds_read_b128 v[40:43], v8 offset:0
    ds_read_b128 v[44:47], v9 offset:0
    s_waitcnt vmcnt(7)
    s_cbranch_vccnz L_w83
    s_waitcnt vmcnt(4)
L_w83:
    buffer_load_dwordx4 v[220:223], v1, s[52:55], s61 offen offset:3072 nt
    s_waitcnt lgkmcnt(0)
    v_mfma_f32_16x16x32_bf16 v[76:79], v[32:35], v[16:19], 0
    v_mfma_f32_16x16x32_bf16 v[76:79], v[36:39], v[20:23], v[76:79]
    v_mfma_f32_16x16x32_bf16 v[76:79], v[40:43], v[24:27], v[76:79]
    v_mfma_f32_16x16x32_bf16 v[76:79], v[44:47], v[28:31], v[76:79]
    s_xor_b32 s61, s60, 229376
    s_waitcnt vmcnt(7)
    s_cbranch_vccnz L_w84
    s_waitcnt vmcnt(4)
L_w84:
    buffer_load_dwordx4 v[224:227], v1, s[52:55], s61 offen offset:0 nt
    v_mov_b32 v124, 26
    ds_write_b32 v125, v124
    ds_read_b32 v126, v127
    s_nop 0
    v_cvt_pk_bf16_f32 v68, v76, v77
    v_cvt_pk_bf16_f32 v69, v78, v79
    v_lshlrev_b32 v70, 16, v68
    v_and_b32 v71, s68, v68
    v_lshlrev_b32 v72, 16, v69
    v_and_b32 v73, s68, v69
    v_mul_f32 v70, s69, v70
    v_mul_f32 v71, s69, v71
    v_mul_f32 v72, s69, v72
    v_mul_f32 v73, s69, v73
    v_cvt_pk_bf16_f32 v102, v70, v71
    v_cvt_pk_bf16_f32 v103, v72, v73
    v_lshlrev_b32 v70, 16, v102
    v_and_b32 v71, s68, v102
    v_lshlrev_b32 v72, 16, v103
    v_and_b32 v73, s68, v103
    v_max3_f32 v120, v120, v70, v71
    v_max3_f32 v120, v120, v72, v73
    s_waitcnt vmcnt(7)
    s_cbranch_vccnz L_w85
    s_waitcnt vmcnt(4)
L_w85:
    buffer_load_dwordx4 v[228:231], v1, s[52:55], s61 offen offset:1024 nt
    s_waitcnt lgkmcnt(0)
    v_cmp_ne_u32 vcc, 0, v126
    v_mov_b32 v68, v120
    s_nop 1
    v_permlane16_swap_b32 v120, v68
    v_max_f32 v120, v120, v68
    v_mov_b32 v68, v120
    s_nop 1
    v_permlane32_swap_b32 v120, v68
    v_max_f32 v120, v120, v68
    v_mul_f32 v121, s71, v120
    v_sub_f32 v121, 0, v121
    s_waitcnt vmcnt(7)
    s_cbranch_vccnz L_w86
    s_waitcnt vmcnt(4)
L_w86:
    buffer_load_dwordx4 v[232:235], v1, s[52:55], s61 offen offset:2048 nt
    v_lshlrev_b32 v70, 16, v88
    v_and_b32 v71, s68, v88
    v_lshlrev_b32 v72, 16, v89
    v_and_b32 v73, s68, v89
    v_fma_f32 v70, v70, s71, v121
    v_fma_f32 v71, v71, s71, v121
    v_fma_f32 v72, v72, s71, v121
    v_fma_f32 v73, v73, s71, v121
    v_exp_f32 v70, v70
    v_exp_f32 v71, v71
    v_exp_f32 v72, v72
    v_exp_f32 v73, v73
    v_add_f32 v68, v70, v71
    v_add_f32 v69, v72, v73
    v_add_f32 v122, v122, v68
    v_add_f32 v122, v122, v69
    v_cvt_pk_bf16_f32 v88, v70, v71
    v_cvt_pk_bf16_f32 v89, v72, v73
    v_perm_b32 v48, v88, v88, v80
    v_perm_b32 v49, v88, v88, v81
    v_perm_b32 v50, v88, v88, v82
    v_perm_b32 v51, v88, v88, v83
    v_perm_b32 v52, v88, v88, v84
    v_perm_b32 v53, v88, v88, v85
    v_perm_b32 v54, v88, v88, v86
    v_perm_b32 v55, v88, v88, v87
    s_waitcnt vmcnt(7)
    s_cbranch_vccnz L_w87
    s_waitcnt vmcnt(4)
L_w87:
    buffer_load_dwordx4 v[236:239], v1, s[52:55], s61 offen offset:3072 nt
    v_mfma_f32_16x16x32_bf16 v[64:67], v[48:51], v[128:131], v[64:67]
    v_mfma_f32_16x16x32_bf16 v[64:67], v[52:55], v[132:135], v[64:67]
    v_lshlrev_b32 v70, 16, v90
    v_and_b32 v71, s68, v90
    v_lshlrev_b32 v72, 16, v91
    v_and_b32 v73, s68, v91
    v_fma_f32 v70, v70, s71, v121
    v_fma_f32 v71, v71, s71, v121
    v_fma_f32 v72, v72, s71, v121
    v_fma_f32 v73, v73, s71, v121
    v_exp_f32 v70, v70
    v_exp_f32 v71, v71
    v_exp_f32 v72, v72
    v_exp_f32 v73, v73
    v_add_f32 v68, v70, v71
    v_add_f32 v69, v72, v73
    v_add_f32 v122, v122, v68
    v_add_f32 v122, v122, v69
    v_cvt_pk_bf16_f32 v90, v70, v71
    v_cvt_pk_bf16_f32 v91, v72, v73
    v_perm_b32 v56, v89, v89, v80
    v_perm_b32 v57, v89, v89, v81
    v_perm_b32 v58, v89, v89, v82
    v_perm_b32 v59, v89, v89, v83
    v_perm_b32 v60, v89, v89, v84
    v_perm_b32 v61, v89, v89, v85
    v_perm_b32 v62, v89, v89, v86
    v_perm_b32 v63, v89, v89, v87
    s_xor_b32 s61, s60, 253952
    s_waitcnt vmcnt(7)
    s_cbranch_vccnz L_w88
    s_waitcnt vmcnt(4)
L_w88:
    buffer_load_dwordx4 v[240:243], v1, s[52:55], s61 offen offset:0 nt
    v_mfma_f32_16x16x32_bf16 v[64:67], v[56:59], v[136:139], v[64:67]
    v_mfma_f32_16x16x32_bf16 v[64:67], v[60:63], v[140:143], v[64:67]
    v_mov_b32 v124, 27
    ds_write_b32 v125, v124
    ds_read_b32 v126, v127
    v_lshlrev_b32 v70, 16, v92
    v_and_b32 v71, s68, v92
    v_lshlrev_b32 v72, 16, v93
    v_and_b32 v73, s68, v93
    v_fma_f32 v70, v70, s71, v121
    v_fma_f32 v71, v71, s71, v121
    v_fma_f32 v72, v72, s71, v121
    v_fma_f32 v73, v73, s71, v121
    v_exp_f32 v70, v70
    v_exp_f32 v71, v71
    v_exp_f32 v72, v72
    v_exp_f32 v73, v73
    v_add_f32 v68, v70, v71
    v_add_f32 v69, v72, v73
    v_add_f32 v122, v122, v68
    v_add_f32 v122, v122, v69
    v_cvt_pk_bf16_f32 v92, v70, v71
    v_cvt_pk_bf16_f32 v93, v72, v73
    v_perm_b32 v48, v90, v90, v80
    v_perm_b32 v49, v90, v90, v81
    v_perm_b32 v50, v90, v90, v82
    v_perm_b32 v51, v90, v90, v83
    v_perm_b32 v52, v90, v90, v84
    v_perm_b32 v53, v90, v90, v85
    v_perm_b32 v54, v90, v90, v86
    v_perm_b32 v55, v90, v90, v87
    s_waitcnt vmcnt(7)
    s_cbranch_vccnz L_w89
    s_waitcnt vmcnt(4)
L_w89:
    buffer_load_dwordx4 v[244:247], v1, s[52:55], s61 offen offset:1024 nt
    v_mfma_f32_16x16x32_bf16 v[64:67], v[48:51], v[144:147], v[64:67]
    v_mfma_f32_16x16x32_bf16 v[64:67], v[52:55], v[148:151], v[64:67]
    s_waitcnt lgkmcnt(0)
    v_cmp_ne_u32 vcc, 0, v126
    v_lshlrev_b32 v70, 16, v94
    v_and_b32 v71, s68, v94
    v_lshlrev_b32 v72, 16, v95
    v_and_b32 v73, s68, v95
    v_fma_f32 v70, v70, s71, v121
    v_fma_f32 v71, v71, s71, v121
    v_fma_f32 v72, v72, s71, v121
    v_fma_f32 v73, v73, s71, v121
    v_exp_f32 v70, v70
    v_exp_f32 v71, v71
    v_exp_f32 v72, v72
    v_exp_f32 v73, v73
    v_add_f32 v68, v70, v71
    v_add_f32 v69, v72, v73
    v_add_f32 v122, v122, v68
    v_add_f32 v122, v122, v69
    v_cvt_pk_bf16_f32 v94, v70, v71
    v_cvt_pk_bf16_f32 v95, v72, v73
    v_perm_b32 v56, v91, v91, v80
    v_perm_b32 v57, v91, v91, v81
    v_perm_b32 v58, v91, v91, v82
    v_perm_b32 v59, v91, v91, v83
    v_perm_b32 v60, v91, v91, v84
    v_perm_b32 v61, v91, v91, v85
    v_perm_b32 v62, v91, v91, v86
    v_perm_b32 v63, v91, v91, v87
    s_waitcnt vmcnt(7)
    s_cbranch_vccnz L_w90
    s_waitcnt vmcnt(4)
L_w90:
    buffer_load_dwordx4 v[248:251], v1, s[52:55], s61 offen offset:2048 nt
    v_mfma_f32_16x16x32_bf16 v[64:67], v[56:59], v[152:155], v[64:67]
    v_mfma_f32_16x16x32_bf16 v[64:67], v[60:63], v[156:159], v[64:67]
    v_lshlrev_b32 v70, 16, v96
    v_and_b32 v71, s68, v96
    v_lshlrev_b32 v72, 16, v97
    v_and_b32 v73, s68, v97
    v_fma_f32 v70, v70, s71, v121
    v_fma_f32 v71, v71, s71, v121
    v_fma_f32 v72, v72, s71, v121
    v_fma_f32 v73, v73, s71, v121
    v_exp_f32 v70, v70
    v_exp_f32 v71, v71
    v_exp_f32 v72, v72
    v_exp_f32 v73, v73
    v_add_f32 v68, v70, v71
    v_add_f32 v69, v72, v73
    v_add_f32 v122, v122, v68
    v_add_f32 v122, v122, v69
    v_cvt_pk_bf16_f32 v96, v70, v71
    v_cvt_pk_bf16_f32 v97, v72, v73
    v_perm_b32 v48, v92, v92, v80
    v_perm_b32 v49, v92, v92, v81
    v_perm_b32 v50, v92, v92, v82
    v_perm_b32 v51, v92, v92, v83
    v_perm_b32 v52, v92, v92, v84
    v_perm_b32 v53, v92, v92, v85
    v_perm_b32 v54, v92, v92, v86
    v_perm_b32 v55, v92, v92, v87
    s_waitcnt vmcnt(7)
    s_cbranch_vccnz L_w91
    s_waitcnt vmcnt(4)
L_w91:
    buffer_load_dwordx4 v[252:255], v1, s[52:55], s61 offen offset:3072 nt
    v_mfma_f32_16x16x32_bf16 v[64:67], v[48:51], v[160:163], v[64:67]
    v_mfma_f32_16x16x32_bf16 v[64:67], v[52:55], v[164:167], v[64:67]
    v_lshlrev_b32 v70, 16, v98
    v_and_b32 v71, s68, v98
    v_lshlrev_b32 v72, 16, v99
    v_and_b32 v73, s68, v99
    v_fma_f32 v70, v70, s71, v121
    v_fma_f32 v71, v71, s71, v121
    v_fma_f32 v72, v72, s71, v121
    v_fma_f32 v73, v73, s71, v121
    v_exp_f32 v70, v70
    v_exp_f32 v71, v71
    v_exp_f32 v72, v72
    v_exp_f32 v73, v73
    v_add_f32 v68, v70, v71
    v_add_f32 v69, v72, v73
    v_add_f32 v122, v122, v68
    v_add_f32 v122, v122, v69
    v_cvt_pk_bf16_f32 v98, v70, v71
    v_cvt_pk_bf16_f32 v99, v72, v73
    v_perm_b32 v56, v93, v93, v80
    v_perm_b32 v57, v93, v93, v81
    v_perm_b32 v58, v93, v93, v82
    v_perm_b32 v59, v93, v93, v83
    v_perm_b32 v60, v93, v93, v84
    v_perm_b32 v61, v93, v93, v85
    v_perm_b32 v62, v93, v93, v86
    v_perm_b32 v63, v93, v93, v87
    s_xor_b32 s61, s60, 262144
    s_waitcnt vmcnt(8)
    s_cbranch_vccnz L_w92
    s_waitcnt vmcnt(5)
L_w92:
    buffer_load_dwordx4 v[128:131], v1, s[52:55], s61 offen offset:0 nt
    v_mfma_f32_16x16x32_bf16 v[64:67], v[56:59], v[168:171], v[64:67]
    v_mfma_f32_16x16x32_bf16 v[64:67], v[60:63], v[172:175], v[64:67]
    v_mov_b32 v124, 28
    ds_write_b32 v125, v124
    ds_read_b32 v126, v127
    v_lshlrev_b32 v70, 16, v100
    v_and_b32 v71, s68, v100
    v_lshlrev_b32 v72, 16, v101
    v_and_b32 v73, s68, v101
    v_fma_f32 v70, v70, s71, v121
    v_fma_f32 v71, v71, s71, v121
    v_fma_f32 v72, v72, s71, v121
    v_fma_f32 v73, v73, s71, v121
    v_exp_f32 v70, v70
    v_exp_f32 v71, v71
    v_exp_f32 v72, v72
    v_exp_f32 v73, v73
    v_add_f32 v68, v70, v71
    v_add_f32 v69, v72, v73
    v_add_f32 v122, v122, v68
    v_add_f32 v122, v122, v69
    v_cvt_pk_bf16_f32 v100, v70, v71
    v_cvt_pk_bf16_f32 v101, v72, v73
    v_perm_b32 v48, v94, v94, v80
    v_perm_b32 v49, v94, v94, v81
    v_perm_b32 v50, v94, v94, v82
    v_perm_b32 v51, v94, v94, v83
    v_perm_b32 v52, v94, v94, v84
    v_perm_b32 v53, v94, v94, v85
    v_perm_b32 v54, v94, v94, v86
    v_perm_b32 v55, v94, v94, v87
    s_waitcnt vmcnt(8)
    s_cbranch_vccnz L_w93
    s_waitcnt vmcnt(5)
L_w93:
    buffer_load_dwordx4 v[132:135], v1, s[52:55], s61 offen offset:1024 nt
    v_mfma_f32_16x16x32_bf16 v[64:67], v[48:51], v[176:179], v[64:67]
    v_mfma_f32_16x16x32_bf16 v[64:67], v[52:55], v[180:183], v[64:67]
    s_waitcnt lgkmcnt(0)
    v_cmp_ne_u32 vcc, 0, v126
    v_lshlrev_b32 v70, 16, v102
    v_and_b32 v71, s68, v102
    v_lshlrev_b32 v72, 16, v103
    v_and_b32 v73, s68, v103
    v_fma_f32 v70, v70, s71, v121
    v_fma_f32 v71, v71, s71, v121
    v_fma_f32 v72, v72, s71, v121
    v_fma_f32 v73, v73, s71, v121
    v_exp_f32 v70, v70
    v_exp_f32 v71, v71
    v_exp_f32 v72, v72
    v_exp_f32 v73, v73
    v_add_f32 v68, v70, v71
    v_add_f32 v69, v72, v73
    v_add_f32 v122, v122, v68
    v_add_f32 v122, v122, v69
    v_cvt_pk_bf16_f32 v102, v70, v71
    v_cvt_pk_bf16_f32 v103, v72, v73
    v_perm_b32 v56, v95, v95, v80
    v_perm_b32 v57, v95, v95, v81
    v_perm_b32 v58, v95, v95, v82
    v_perm_b32 v59, v95, v95, v83
    v_perm_b32 v60, v95, v95, v84
    v_perm_b32 v61, v95, v95, v85
    v_perm_b32 v62, v95, v95, v86
    v_perm_b32 v63, v95, v95, v87
    s_waitcnt vmcnt(8)
    s_cbranch_vccnz L_w94
    s_waitcnt vmcnt(5)
L_w94:
    buffer_load_dwordx4 v[136:139], v1, s[52:55], s61 offen offset:2048 nt
    v_mfma_f32_16x16x32_bf16 v[64:67], v[56:59], v[184:187], v[64:67]
    v_mfma_f32_16x16x32_bf16 v[64:67], v[60:63], v[188:191], v[64:67]
    v_lshlrev_b32 v70, 16, v104
    v_and_b32 v71, s68, v104
    v_lshlrev_b32 v72, 16, v105
    v_and_b32 v73, s68, v105
    v_fma_f32 v70, v70, s71, v121
    v_fma_f32 v71, v71, s71, v121
    v_fma_f32 v72, v72, s71, v121
    v_fma_f32 v73, v73, s71, v121
    v_exp_f32 v70, v70
    v_exp_f32 v71, v71
    v_exp_f32 v72, v72
    v_exp_f32 v73, v73
    v_add_f32 v68, v70, v71
    v_add_f32 v69, v72, v73
    v_add_f32 v122, v122, v68
    v_add_f32 v122, v122, v69
    v_cvt_pk_bf16_f32 v104, v70, v71
    v_cvt_pk_bf16_f32 v105, v72, v73
    v_perm_b32 v48, v96, v96, v80
    v_perm_b32 v49, v96, v96, v81
    v_perm_b32 v50, v96, v96, v82
    v_perm_b32 v51, v96, v96, v83
    v_perm_b32 v52, v96, v96, v84
    v_perm_b32 v53, v96, v96, v85
    v_perm_b32 v54, v96, v96, v86
    v_perm_b32 v55, v96, v96, v87
    s_waitcnt vmcnt(8)
    s_cbranch_vccnz L_w95
    s_waitcnt vmcnt(5)
L_w95:
    buffer_load_dwordx4 v[140:143], v1, s[52:55], s61 offen offset:3072 nt
    v_mfma_f32_16x16x32_bf16 v[64:67], v[48:51], v[192:195], v[64:67]
    v_mfma_f32_16x16x32_bf16 v[64:67], v[52:55], v[196:199], v[64:67]
    v_lshlrev_b32 v70, 16, v106
    v_and_b32 v71, s68, v106
    v_lshlrev_b32 v72, 16, v107
    v_and_b32 v73, s68, v107
    v_fma_f32 v70, v70, s71, v121
    v_fma_f32 v71, v71, s71, v121
    v_fma_f32 v72, v72, s71, v121
    v_fma_f32 v73, v73, s71, v121
    v_exp_f32 v70, v70
    v_exp_f32 v71, v71
    v_exp_f32 v72, v72
    v_exp_f32 v73, v73
    v_add_f32 v68, v70, v71
    v_add_f32 v69, v72, v73
    v_add_f32 v122, v122, v68
    v_add_f32 v122, v122, v69
    v_cvt_pk_bf16_f32 v106, v70, v71
    v_cvt_pk_bf16_f32 v107, v72, v73
    v_perm_b32 v56, v97, v97, v80
    v_perm_b32 v57, v97, v97, v81
    v_perm_b32 v58, v97, v97, v82
    v_perm_b32 v59, v97, v97, v83
    v_perm_b32 v60, v97, v97, v84
    v_perm_b32 v61, v97, v97, v85
    v_perm_b32 v62, v97, v97, v86
    v_perm_b32 v63, v97, v97, v87
    s_xor_b32 s61, s60, 286720
    s_waitcnt vmcnt(8)
    s_cbranch_vccnz L_w96
    s_waitcnt vmcnt(5)
L_w96:
    buffer_load_dwordx4 v[144:147], v1, s[52:55], s61 offen offset:0 nt
    v_mfma_f32_16x16x32_bf16 v[64:67], v[56:59], v[200:203], v[64:67]
    v_mfma_f32_16x16x32_bf16 v[64:67], v[60:63], v[204:207], v[64:67]
    v_mov_b32 v124, 29
    ds_write_b32 v125, v124
    ds_read_b32 v126, v127
    v_lshlrev_b32 v70, 16, v108
    v_and_b32 v71, s68, v108
    v_lshlrev_b32 v72, 16, v109
    v_and_b32 v73, s68, v109
    v_fma_f32 v70, v70, s71, v121
    v_fma_f32 v71, v71, s71, v121
    v_fma_f32 v72, v72, s71, v121
    v_fma_f32 v73, v73, s71, v121
    v_exp_f32 v70, v70
    v_exp_f32 v71, v71
    v_exp_f32 v72, v72
    v_exp_f32 v73, v73
    v_add_f32 v68, v70, v71
    v_add_f32 v69, v72, v73
    v_add_f32 v122, v122, v68
    v_add_f32 v122, v122, v69
    v_cvt_pk_bf16_f32 v108, v70, v71
    v_cvt_pk_bf16_f32 v109, v72, v73
    v_perm_b32 v48, v98, v98, v80
    v_perm_b32 v49, v98, v98, v81
    v_perm_b32 v50, v98, v98, v82
    v_perm_b32 v51, v98, v98, v83
    v_perm_b32 v52, v98, v98, v84
    v_perm_b32 v53, v98, v98, v85
    v_perm_b32 v54, v98, v98, v86
    v_perm_b32 v55, v98, v98, v87
    s_waitcnt vmcnt(8)
    s_cbranch_vccnz L_w97
    s_waitcnt vmcnt(5)
L_w97:
    buffer_load_dwordx4 v[148:151], v1, s[52:55], s61 offen offset:1024 nt
    v_mfma_f32_16x16x32_bf16 v[64:67], v[48:51], v[208:211], v[64:67]
    v_mfma_f32_16x16x32_bf16 v[64:67], v[52:55], v[212:215], v[64:67]
    s_waitcnt lgkmcnt(0)
    v_cmp_ne_u32 vcc, 0, v126
    v_lshlrev_b32 v70, 16, v110
    v_and_b32 v71, s68, v110
    v_lshlrev_b32 v72, 16, v111
    v_and_b32 v73, s68, v111
    v_fma_f32 v70, v70, s71, v121
    v_fma_f32 v71, v71, s71, v121
    v_fma_f32 v72, v72, s71, v121
    v_fma_f32 v73, v73, s71, v121
    v_exp_f32 v70, v70
    v_exp_f32 v71, v71
    v_exp_f32 v72, v72
    v_exp_f32 v73, v73
    v_add_f32 v68, v70, v71
    v_add_f32 v69, v72, v73
    v_add_f32 v122, v122, v68
    v_add_f32 v122, v122, v69
    v_cvt_pk_bf16_f32 v110, v70, v71
    v_cvt_pk_bf16_f32 v111, v72, v73
    v_perm_b32 v56, v99, v99, v80
    v_perm_b32 v57, v99, v99, v81
    v_perm_b32 v58, v99, v99, v82
    v_perm_b32 v59, v99, v99, v83
    v_perm_b32 v60, v99, v99, v84
    v_perm_b32 v61, v99, v99, v85
    v_perm_b32 v62, v99, v99, v86
    v_perm_b32 v63, v99, v99, v87
    s_waitcnt vmcnt(8)
    s_cbranch_vccnz L_w98
    s_waitcnt vmcnt(5)
L_w98:
    buffer_load_dwordx4 v[152:155], v1, s[52:55], s61 offen offset:2048 nt
    v_mfma_f32_16x16x32_bf16 v[64:67], v[56:59], v[216:219], v[64:67]
    v_mfma_f32_16x16x32_bf16 v[64:67], v[60:63], v[220:223], v[64:67]
    v_lshlrev_b32 v70, 16, v112
    v_and_b32 v71, s68, v112
    v_lshlrev_b32 v72, 16, v113
    v_and_b32 v73, s68, v113
    v_fma_f32 v70, v70, s71, v121
    v_fma_f32 v71, v71, s71, v121
    v_fma_f32 v72, v72, s71, v121
    v_fma_f32 v73, v73, s71, v121
    v_exp_f32 v70, v70
    v_exp_f32 v71, v71
    v_exp_f32 v72, v72
    v_exp_f32 v73, v73
    v_add_f32 v68, v70, v71
    v_add_f32 v69, v72, v73
    v_add_f32 v122, v122, v68
    v_add_f32 v122, v122, v69
    v_cvt_pk_bf16_f32 v112, v70, v71
    v_cvt_pk_bf16_f32 v113, v72, v73
    v_perm_b32 v48, v100, v100, v80
    v_perm_b32 v49, v100, v100, v81
    v_perm_b32 v50, v100, v100, v82
    v_perm_b32 v51, v100, v100, v83
    v_perm_b32 v52, v100, v100, v84
    v_perm_b32 v53, v100, v100, v85
    v_perm_b32 v54, v100, v100, v86
    v_perm_b32 v55, v100, v100, v87
    s_waitcnt vmcnt(8)
    s_cbranch_vccnz L_w99
    s_waitcnt vmcnt(5)
L_w99:
    buffer_load_dwordx4 v[156:159], v1, s[52:55], s61 offen offset:3072 nt
    v_mfma_f32_16x16x32_bf16 v[64:67], v[48:51], v[224:227], v[64:67]
    v_mfma_f32_16x16x32_bf16 v[64:67], v[52:55], v[228:231], v[64:67]
    v_lshlrev_b32 v70, 16, v114
    v_and_b32 v71, s68, v114
    v_lshlrev_b32 v72, 16, v115
    v_and_b32 v73, s68, v115
    v_fma_f32 v70, v70, s71, v121
    v_fma_f32 v71, v71, s71, v121
    v_fma_f32 v72, v72, s71, v121
    v_fma_f32 v73, v73, s71, v121
    v_exp_f32 v70, v70
    v_exp_f32 v71, v71
    v_exp_f32 v72, v72
    v_exp_f32 v73, v73
    v_add_f32 v68, v70, v71
    v_add_f32 v69, v72, v73
    v_add_f32 v122, v122, v68
    v_add_f32 v122, v122, v69
    v_cvt_pk_bf16_f32 v114, v70, v71
    v_cvt_pk_bf16_f32 v115, v72, v73
    v_perm_b32 v56, v101, v101, v80
    v_perm_b32 v57, v101, v101, v81
    v_perm_b32 v58, v101, v101, v82
    v_perm_b32 v59, v101, v101, v83
    v_perm_b32 v60, v101, v101, v84
    v_perm_b32 v61, v101, v101, v85
    v_perm_b32 v62, v101, v101, v86
    v_perm_b32 v63, v101, v101, v87
    s_xor_b32 s61, s60, 360448
    s_waitcnt vmcnt(8)
    s_cbranch_vccnz L_w100
    s_waitcnt vmcnt(5)
L_w100:
    buffer_load_dwordx4 v[160:163], v1, s[52:55], s61 offen offset:0 nt
    v_mfma_f32_16x16x32_bf16 v[64:67], v[56:59], v[232:235], v[64:67]
    v_mfma_f32_16x16x32_bf16 v[64:67], v[60:63], v[236:239], v[64:67]
    v_mov_b32 v124, 30
    ds_write_b32 v125, v124
    ds_read_b32 v126, v127
    v_lshlrev_b32 v70, 16, v116
    v_and_b32 v71, s68, v116
    v_lshlrev_b32 v72, 16, v117
    v_and_b32 v73, s68, v117
    v_fma_f32 v70, v70, s71, v121
    v_fma_f32 v71, v71, s71, v121
    v_fma_f32 v72, v72, s71, v121
    v_fma_f32 v73, v73, s71, v121
    v_exp_f32 v70, v70
    v_exp_f32 v71, v71
    v_exp_f32 v72, v72
    v_exp_f32 v73, v73
    v_add_f32 v68, v70, v71
    v_add_f32 v69, v72, v73
    v_add_f32 v122, v122, v68
    v_add_f32 v122, v122, v69
    v_cvt_pk_bf16_f32 v116, v70, v71
    v_cvt_pk_bf16_f32 v117, v72, v73
    v_perm_b32 v48, v102, v102, v80
    v_perm_b32 v49, v102, v102, v81
    v_perm_b32 v50, v102, v102, v82
    v_perm_b32 v51, v102, v102, v83
    v_perm_b32 v52, v102, v102, v84
    v_perm_b32 v53, v102, v102, v85
    v_perm_b32 v54, v102, v102, v86
    v_perm_b32 v55, v102, v102, v87
    s_waitcnt vmcnt(8)
    s_cbranch_vccnz L_w101
    s_waitcnt vmcnt(5)
L_w101:
    buffer_load_dwordx4 v[164:167], v1, s[52:55], s61 offen offset:1024 nt
    v_mfma_f32_16x16x32_bf16 v[64:67], v[48:51], v[240:243], v[64:67]
    v_mfma_f32_16x16x32_bf16 v[64:67], v[52:55], v[244:247], v[64:67]
    s_waitcnt lgkmcnt(0)
    v_cmp_ne_u32 vcc, 0, v126
    v_lshlrev_b32 v70, 16, v118
    v_and_b32 v71, s68, v118
    v_lshlrev_b32 v72, 16, v119
    v_and_b32 v73, s68, v119
    v_fma_f32 v70, v70, s71, v121
    v_fma_f32 v71, v71, s71, v121
    v_fma_f32 v72, v72, s71, v121
    v_fma_f32 v73, v73, s71, v121
    v_exp_f32 v70, v70
    v_exp_f32 v71, v71
    v_exp_f32 v72, v72
    v_exp_f32 v73, v73
    v_add_f32 v68, v70, v71
    v_add_f32 v69, v72, v73
    v_add_f32 v122, v122, v68
    v_add_f32 v122, v122, v69
    v_cvt_pk_bf16_f32 v118, v70, v71
    v_cvt_pk_bf16_f32 v119, v72, v73
    v_perm_b32 v56, v103, v103, v80
    v_perm_b32 v57, v103, v103, v81
    v_perm_b32 v58, v103, v103, v82
    v_perm_b32 v59, v103, v103, v83
    v_perm_b32 v60, v103, v103, v84
    v_perm_b32 v61, v103, v103, v85
    v_perm_b32 v62, v103, v103, v86
    v_perm_b32 v63, v103, v103, v87
    s_waitcnt vmcnt(8)
    s_cbranch_vccnz L_w102
    s_waitcnt vmcnt(5)
L_w102:
    buffer_load_dwordx4 v[168:171], v1, s[52:55], s61 offen offset:2048 nt
    v_mfma_f32_16x16x32_bf16 v[64:67], v[56:59], v[248:251], v[64:67]
    v_mfma_f32_16x16x32_bf16 v[64:67], v[60:63], v[252:255], v[64:67]
    v_mov_b32 v68, v122
    s_nop 1
    v_permlane16_swap_b32 v122, v68
    v_add_f32 v122, v122, v68
    v_mov_b32 v68, v122
    s_nop 1
    v_permlane32_swap_b32 v122, v68
    v_add_f32 v122, v122, v68
    v_sub_f32 v70, 0, v121
    v_mov_b32 v71, v122
    v_bfe_u32 v68, v0, 3, 1
    v_lshlrev_b32 v68, 5, v68
    s_lshl_b32 s63, s3, 3
    s_add_u32 s63, s63, 145408
    v_add_u32 v68, s63, v68
    ds_write_b64 v68, v[70:71]
    s_mov_b64 exec, 1
    v_mov_b32 v68, 145508
    v_mov_b32 v69, 1
    ds_add_u32 v68, v69
    s_mov_b64 exec, -1
    s_lshl_b32 s63, s3, 10
    s_add_u32 s63, s63, 145664
    v_add_u32 v15, s63, v1
    v_lshrrev_b32 v2, 5, v0
    v_lshlrev_b32 v3, 5, v2
    v_add_u32 v3, 145408, v3
    s_lshl_b32 s63, s3, 3
    v_add_u32 v9, s63, v3
    v_lshlrev_b32 v4, 3, v0
    v_lshlrev_b32 v5, 2, v2
    v_and_b32 v6, 1, v0
    v_lshl_add_u32 v6, v2, 1, v6
    v_bfe_u32 v7, v0, 1, 4
    v_lshl_add_u32 v6, v6, 4, v7
    v_lshlrev_b32 v6, 4, v6
    v_add_u32 v6, 145664, v6
    s_lshr_b32 s62, s9, 1
    s_and_b32 s63, s9, 1
    s_lshl_b32 s63, s63, 3
    s_add_u32 s62, s62, s63
    s_mul_i32 s63, s62, 528
    s_add_u32 s63, s63, 149760
    v_add_u32 v7, s63, v4
    s_lshl_b32 s63, s62, 3
    s_add_u32 s63, s63, 145536
    v_add_u32 v8, s63, v5
    v_and_b32 v2, 15, v0
    v_lshl_add_u32 v5, v2, 3, v5
    s_lshl_b32 s63, s8, 4
    s_add_u32 s63, s63, s62
    s_mul_i32 s63, s63, 640
    s_add_u32 s63, s63, 458752
    v_perm_b32 v48, v104, v104, v80
    v_perm_b32 v49, v104, v104, v81
    v_perm_b32 v50, v104, v104, v82
    v_perm_b32 v51, v104, v104, v83
    v_perm_b32 v52, v104, v104, v84
    v_perm_b32 v53, v104, v104, v85
    v_perm_b32 v54, v104, v104, v86
    v_perm_b32 v55, v104, v104, v87
    s_waitcnt vmcnt(8)
    s_cbranch_vccnz L_w103
    s_waitcnt vmcnt(5)
L_w103:
    buffer_load_dwordx4 v[172:175], v1, s[52:55], s61 offen offset:3072 nt
    v_mfma_f32_16x16x32_bf16 v[64:67], v[48:51], v[128:131], v[64:67]
    v_mfma_f32_16x16x32_bf16 v[64:67], v[52:55], v[132:135], v[64:67]
    v_perm_b32 v56, v105, v105, v80
    v_perm_b32 v57, v105, v105, v81
    v_perm_b32 v58, v105, v105, v82
    v_perm_b32 v59, v105, v105, v83
    v_perm_b32 v60, v105, v105, v84
    v_perm_b32 v61, v105, v105, v85
    v_perm_b32 v62, v105, v105, v86
    v_perm_b32 v63, v105, v105, v87
    s_xor_b32 s61, s60, 385024
    s_waitcnt vmcnt(8)
    s_cbranch_vccnz L_w104
    s_waitcnt vmcnt(5)
L_w104:
    buffer_load_dwordx4 v[176:179], v1, s[52:55], s61 offen offset:0 nt
    v_mfma_f32_16x16x32_bf16 v[64:67], v[56:59], v[136:139], v[64:67]
    v_mfma_f32_16x16x32_bf16 v[64:67], v[60:63], v[140:143], v[64:67]
    v_mov_b32 v124, 31
    ds_write_b32 v125, v124
    ds_read_b32 v126, v127
    v_perm_b32 v48, v106, v106, v80
    v_perm_b32 v49, v106, v106, v81
    v_perm_b32 v50, v106, v106, v82
    v_perm_b32 v51, v106, v106, v83
    s_waitcnt vmcnt(8)
    s_cbranch_vccnz L_w105
    s_waitcnt vmcnt(5)
L_w105:
    buffer_load_dwordx4 v[180:183], v1, s[52:55], s61 offen offset:1024 nt
    v_mfma_f32_16x16x32_bf16 v[64:67], v[48:51], v[144:147], v[64:67]
    s_waitcnt lgkmcnt(0)
    v_cmp_ne_u32 vcc, 0, v126
    v_perm_b32 v52, v106, v106, v84
    v_perm_b32 v53, v106, v106, v85
    v_perm_b32 v54, v106, v106, v86
    v_perm_b32 v55, v106, v106, v87
    s_waitcnt vmcnt(8)
    s_cbranch_vccnz L_w106
    s_waitcnt vmcnt(5)
L_w106:
    buffer_load_dwordx4 v[184:187], v1, s[52:55], s61 offen offset:2048 nt
    v_mfma_f32_16x16x32_bf16 v[64:67], v[52:55], v[148:151], v[64:67]
    v_perm_b32 v56, v107, v107, v80
    v_perm_b32 v57, v107, v107, v81
    v_perm_b32 v58, v107, v107, v82
    v_perm_b32 v59, v107, v107, v83
    s_waitcnt vmcnt(8)
    s_cbranch_vccnz L_w107
    s_waitcnt vmcnt(5)
L_w107:
    buffer_load_dwordx4 v[188:191], v1, s[52:55], s61 offen offset:3072 nt
    v_mfma_f32_16x16x32_bf16 v[64:67], v[56:59], v[152:155], v[64:67]
    v_perm_b32 v60, v107, v107, v84
    v_perm_b32 v61, v107, v107, v85
    v_perm_b32 v62, v107, v107, v86
    v_perm_b32 v63, v107, v107, v87
    s_xor_b32 s61, s60, 393216
    s_waitcnt vmcnt(8)
    s_cbranch_vccnz L_w108
    s_waitcnt vmcnt(5)
L_w108:
    buffer_load_dwordx4 v[192:195], v1, s[52:55], s61 offen offset:0 nt
    v_mfma_f32_16x16x32_bf16 v[64:67], v[60:63], v[156:159], v[64:67]
    v_mov_b32 v124, 32
    ds_write_b32 v125, v124
    ds_read_b32 v126, v127
    v_perm_b32 v48, v108, v108, v80
    v_perm_b32 v49, v108, v108, v81
    v_perm_b32 v50, v108, v108, v82
    v_perm_b32 v51, v108, v108, v83
    s_waitcnt vmcnt(8)
    s_cbranch_vccnz L_w109
    s_waitcnt vmcnt(5)
L_w109:
    buffer_load_dwordx4 v[196:199], v1, s[52:55], s61 offen offset:1024 nt
    v_mfma_f32_16x16x32_bf16 v[64:67], v[48:51], v[160:163], v[64:67]
    s_waitcnt lgkmcnt(0)
    v_cmp_ne_u32 vcc, 0, v126
    v_perm_b32 v52, v108, v108, v84
    v_perm_b32 v53, v108, v108, v85
    v_perm_b32 v54, v108, v108, v86
    v_perm_b32 v55, v108, v108, v87
    s_waitcnt vmcnt(8)
    s_cbranch_vccnz L_w110
    s_waitcnt vmcnt(5)
L_w110:
    buffer_load_dwordx4 v[200:203], v1, s[52:55], s61 offen offset:2048 nt
    v_mfma_f32_16x16x32_bf16 v[64:67], v[52:55], v[164:167], v[64:67]
    v_perm_b32 v56, v109, v109, v80
    v_perm_b32 v57, v109, v109, v81
    v_perm_b32 v58, v109, v109, v82
    v_perm_b32 v59, v109, v109, v83
    s_waitcnt vmcnt(8)
    s_cbranch_vccnz L_w111
    s_waitcnt vmcnt(5)
L_w111:
    buffer_load_dwordx4 v[204:207], v1, s[52:55], s61 offen offset:3072 nt
    v_mfma_f32_16x16x32_bf16 v[64:67], v[56:59], v[168:171], v[64:67]
    v_perm_b32 v60, v109, v109, v84
    v_perm_b32 v61, v109, v109, v85
    v_perm_b32 v62, v109, v109, v86
    v_perm_b32 v63, v109, v109, v87
    s_xor_b32 s61, s60, 417792
    s_waitcnt vmcnt(8)
    s_cbranch_vccnz L_w112
    s_waitcnt vmcnt(5)
L_w112:
    buffer_load_dwordx4 v[208:211], v1, s[52:55], s61 offen offset:0 nt
    v_mfma_f32_16x16x32_bf16 v[64:67], v[60:63], v[172:175], v[64:67]
    v_mov_b32 v124, 33
    ds_write_b32 v125, v124
    ds_read_b32 v126, v127
    v_perm_b32 v48, v110, v110, v80
    v_perm_b32 v49, v110, v110, v81
    v_perm_b32 v50, v110, v110, v82
    v_perm_b32 v51, v110, v110, v83
    s_waitcnt vmcnt(8)
    s_cbranch_vccnz L_w113
    s_waitcnt vmcnt(5)
L_w113:
    buffer_load_dwordx4 v[212:215], v1, s[52:55], s61 offen offset:1024 nt
    v_mfma_f32_16x16x32_bf16 v[64:67], v[48:51], v[176:179], v[64:67]
    s_waitcnt lgkmcnt(0)
    v_cmp_ne_u32 vcc, 0, v126
    v_perm_b32 v52, v110, v110, v84
    v_perm_b32 v53, v110, v110, v85
    v_perm_b32 v54, v110, v110, v86
    v_perm_b32 v55, v110, v110, v87
    s_waitcnt vmcnt(8)
    s_cbranch_vccnz L_w114
    s_waitcnt vmcnt(5)
L_w114:
    buffer_load_dwordx4 v[216:219], v1, s[52:55], s61 offen offset:2048 nt
    v_mfma_f32_16x16x32_bf16 v[64:67], v[52:55], v[180:183], v[64:67]
    v_perm_b32 v56, v111, v111, v80
    v_perm_b32 v57, v111, v111, v81
    v_perm_b32 v58, v111, v111, v82
    v_perm_b32 v59, v111, v111, v83
    s_waitcnt vmcnt(8)
    s_cbranch_vccnz L_w115
    s_waitcnt vmcnt(5)
L_w115:
    buffer_load_dwordx4 v[220:223], v1, s[52:55], s61 offen offset:3072 nt
    v_mfma_f32_16x16x32_bf16 v[64:67], v[56:59], v[184:187], v[64:67]
    v_perm_b32 v60, v111, v111, v84
    v_perm_b32 v61, v111, v111, v85
    v_perm_b32 v62, v111, v111, v86
    v_perm_b32 v63, v111, v111, v87
    s_xor_b32 s61, s60, 491520
    s_waitcnt vmcnt(8)
    s_cbranch_vccnz L_w116
    s_waitcnt vmcnt(5)
L_w116:
    buffer_load_dwordx4 v[224:227], v1, s[52:55], s61 offen offset:0 nt
    v_mfma_f32_16x16x32_bf16 v[64:67], v[60:63], v[188:191], v[64:67]
    v_mov_b32 v124, 34
    ds_write_b32 v125, v124
    ds_read_b32 v126, v127
    v_perm_b32 v48, v112, v112, v80
    v_perm_b32 v49, v112, v112, v81
    v_perm_b32 v50, v112, v112, v82
    v_perm_b32 v51, v112, v112, v83
    s_waitcnt vmcnt(8)
    s_cbranch_vccnz L_w117
    s_waitcnt vmcnt(5)
L_w117:
    buffer_load_dwordx4 v[228:231], v1, s[52:55], s61 offen offset:1024 nt
    v_mfma_f32_16x16x32_bf16 v[64:67], v[48:51], v[192:195], v[64:67]
    s_waitcnt lgkmcnt(0)
    v_cmp_ne_u32 vcc, 0, v126
    v_perm_b32 v52, v112, v112, v84
    v_perm_b32 v53, v112, v112, v85
    v_perm_b32 v54, v112, v112, v86
    v_perm_b32 v55, v112, v112, v87
    s_waitcnt vmcnt(8)
    s_cbranch_vccnz L_w118
    s_waitcnt vmcnt(5)
L_w118:
    buffer_load_dwordx4 v[232:235], v1, s[52:55], s61 offen offset:2048 nt
    v_mfma_f32_16x16x32_bf16 v[64:67], v[52:55], v[196:199], v[64:67]
    v_perm_b32 v56, v113, v113, v80
    v_perm_b32 v57, v113, v113, v81
    v_perm_b32 v58, v113, v113, v82
    v_perm_b32 v59, v113, v113, v83
    s_waitcnt vmcnt(8)
    s_cbranch_vccnz L_w119
    s_waitcnt vmcnt(5)
L_w119:
    buffer_load_dwordx4 v[236:239], v1, s[52:55], s61 offen offset:3072 nt
    v_mfma_f32_16x16x32_bf16 v[64:67], v[56:59], v[200:203], v[64:67]
    v_perm_b32 v60, v113, v113, v84
    v_perm_b32 v61, v113, v113, v85
    v_perm_b32 v62, v113, v113, v86
    v_perm_b32 v63, v113, v113, v87
    s_xor_b32 s61, s60, 516096
    s_waitcnt vmcnt(8)
    s_cbranch_vccnz L_w120
    s_waitcnt vmcnt(5)
L_w120:
    buffer_load_dwordx4 v[240:243], v1, s[52:55], s61 offen offset:0 nt
    v_mfma_f32_16x16x32_bf16 v[64:67], v[60:63], v[204:207], v[64:67]
    v_mov_b32 v124, 35
    ds_write_b32 v125, v124
    ds_read_b32 v126, v127
    v_mov_b32 v68, 145508
    s_mov_b32 s70, 16000000
L_fw:
    ds_read_b32 v69, v68
    ds_read_b128 v[16:19], v3
    ds_read_b128 v[20:23], v3 offset:16
    ds_read_b32 v9, v9
    s_waitcnt lgkmcnt(0)
    v_readfirstlane_b32 s5, v69
    s_cmp_ge_u32 s5, 4
    s_cbranch_scc1 L_fd
    s_sub_u32 s70, s70, 1
    s_cbranch_scc1 L_fd
    s_lshl_b32 s5, s3, 3
    v_add_u32 v9, s5, v3
    s_branch L_fw
L_fd:
    v_max3_f32 v24, v16, v18, v20
    v_max_f32 v24, v24, v22
    v_sub_f32 v16, v16, v24
    v_sub_f32 v18, v18, v24
    v_sub_f32 v20, v20, v24
    v_sub_f32 v22, v22, v24
    v_sub_f32 v9, v9, v24
    v_exp_f32 v16, v16
    v_exp_f32 v18, v18
    v_exp_f32 v20, v20
    v_exp_f32 v22, v22
    v_exp_f32 v9, v9
    v_mul_f32 v25, v16, v17
    v_fmac_f32 v25, v18, v19
    v_fmac_f32 v25, v20, v21
    v_fmac_f32 v25, v22, v23
    v_rcp_f32 v26, v25
    v_log_f32 v27, v25
    v_mul_f32 v9, v9, v26
    v_add_f32 v27, v27, v24
    v_min_u32 v27, -2, v27
    v_perm_b32 v48, v114, v114, v80
    v_perm_b32 v49, v114, v114, v81
    v_perm_b32 v50, v114, v114, v82
    v_perm_b32 v51, v114, v114, v83
    s_waitcnt vmcnt(8)
    s_cbranch_vccnz L_w121
    s_waitcnt vmcnt(5)
L_w121:
    buffer_load_dwordx4 v[244:247], v1, s[52:55], s61 offen offset:1024 nt
    v_mfma_f32_16x16x32_bf16 v[64:67], v[48:51], v[208:211], v[64:67]
    s_waitcnt lgkmcnt(0)
    v_cmp_ne_u32 vcc, 0, v126
    v_perm_b32 v52, v114, v114, v84
    v_perm_b32 v53, v114, v114, v85
    v_perm_b32 v54, v114, v114, v86
    v_perm_b32 v55, v114, v114, v87
    s_waitcnt vmcnt(8)
    s_cbranch_vccnz L_w122
    s_waitcnt vmcnt(5)
L_w122:
    buffer_load_dwordx4 v[248:251], v1, s[52:55], s61 offen offset:2048 nt
    v_mfma_f32_16x16x32_bf16 v[64:67], v[52:55], v[212:215], v[64:67]
    v_perm_b32 v56, v115, v115, v80
    v_perm_b32 v57, v115, v115, v81
    v_perm_b32 v58, v115, v115, v82
    v_perm_b32 v59, v115, v115, v83
    s_waitcnt vmcnt(8)
    s_cbranch_vccnz L_w123
    s_waitcnt vmcnt(5)
L_w123:
    buffer_load_dwordx4 v[252:255], v1, s[52:55], s61 offen offset:3072 nt
    v_mfma_f32_16x16x32_bf16 v[64:67], v[56:59], v[216:219], v[64:67]
    s_mov_b32 m0, s67
    s_sub_u32 s5, s2, 144
    s_cmp_lt_u32 s5, 64
    s_cbranch_scc1 L_tq
    v_perm_b32 v60, v115, v115, v84
    v_perm_b32 v61, v115, v115, v85
    v_perm_b32 v62, v115, v115, v86
    v_perm_b32 v63, v115, v115, v87
    v_perm_b32 v48, v116, v116, v80
    v_perm_b32 v49, v116, v116, v81
    v_perm_b32 v50, v116, v116, v82
    v_perm_b32 v51, v116, v116, v83
    v_perm_b32 v52, v116, v116, v84
    v_perm_b32 v53, v116, v116, v85
    v_perm_b32 v54, v116, v116, v86
    v_perm_b32 v55, v116, v116, v87
    v_perm_b32 v56, v117, v117, v80
    v_perm_b32 v57, v117, v117, v81
    v_perm_b32 v58, v117, v117, v82
    v_perm_b32 v59, v117, v117, v83
    s_waitcnt vmcnt(5)
    buffer_load_dwordx4 v123, s[44:47], s72 offen nt lds
    s_add_u32 s72, s72, s73
    s_add_u32 m0, m0, 1024
    s_nop 0
    buffer_load_dwordx4 v123, s[44:47], s72 offen nt lds
    s_add_u32 s72, s72, s73
    s_add_u32 m0, m0, 1024
    v_mfma_f32_16x16x32_bf16 v[64:67], v[60:63], v[220:223], v[64:67]
    v_mfma_f32_16x16x32_bf16 v[64:67], v[48:51], v[224:227], v[64:67]
    v_mfma_f32_16x16x32_bf16 v[64:67], v[52:55], v[228:231], v[64:67]
    v_mfma_f32_16x16x32_bf16 v[64:67], v[56:59], v[232:235], v[64:67]
    v_perm_b32 v60, v117, v117, v84
    v_perm_b32 v61, v117, v117, v85
    v_perm_b32 v62, v117, v117, v86
    v_perm_b32 v63, v117, v117, v87
    s_waitcnt vmcnt(6)
    buffer_load_dwordx4 v123, s[44:47], s72 offen nt lds
    s_add_u32 s72, s72, s74
    s_add_u32 m0, m0, 1024
    s_nop 0
    buffer_load_dwordx4 v123, s[44:47], s72 offen nt lds
    s_add_u32 s72, s72, s73
    s_add_u32 m0, m0, 1024
    v_mfma_f32_16x16x32_bf16 v[64:67], v[60:63], v[236:239], v[64:67]
    v_perm_b32 v48, v118, v118, v80
    v_perm_b32 v49, v118, v118, v81
    v_perm_b32 v50, v118, v118, v82
    v_perm_b32 v51, v118, v118, v83
    s_waitcnt vmcnt(7)
    buffer_load_dwordx4 v123, s[44:47], s72 offen nt lds
    s_add_u32 s72, s72, s73
    s_add_u32 m0, m0, 1024
    s_nop 0
    buffer_load_dwordx4 v123, s[44:47], s72 offen nt lds
    s_add_u32 s72, s72, s74
    s_add_u32 m0, m0, 1024
    v_mfma_f32_16x16x32_bf16 v[64:67], v[48:51], v[240:243], v[64:67]
    v_perm_b32 v52, v118, v118, v84
    v_perm_b32 v53, v118, v118, v85
    v_perm_b32 v54, v118, v118, v86
    v_perm_b32 v55, v118, v118, v87
    s_waitcnt vmcnt(8)
    buffer_load_dwordx4 v123, s[44:47], s72 offen nt lds
    s_add_u32 s72, s72, s73
    s_add_u32 m0, m0, 1024
    v_mfma_f32_16x16x32_bf16 v[64:67], v[52:55], v[244:247], v[64:67]
    v_perm_b32 v56, v119, v119, v80
    v_perm_b32 v57, v119, v119, v81
    v_perm_b32 v58, v119, v119, v82
    v_perm_b32 v59, v119, v119, v83
    s_waitcnt vmcnt(8)
    buffer_load_dwordx4 v123, s[44:47], s72 offen nt lds
    s_add_u32 s72, s72, s73
    s_add_u32 m0, m0, 1024
    v_mfma_f32_16x16x32_bf16 v[64:67], v[56:59], v[248:251], v[64:67]
    v_perm_b32 v60, v119, v119, v84
    v_perm_b32 v61, v119, v119, v85
    v_perm_b32 v62, v119, v119, v86
    v_perm_b32 v63, v119, v119, v87
    s_waitcnt vmcnt(8)
    s_nop 0
    v_mfma_f32_16x16x32_bf16 v[64:67], v[60:63], v[252:255], v[64:67]
    s_branch L_tj
L_tq:
    v_perm_b32 v60, v115, v115, v84
    v_perm_b32 v61, v115, v115, v85
    v_perm_b32 v62, v115, v115, v86
    v_perm_b32 v63, v115, v115, v87
    v_perm_b32 v48, v116, v116, v80
    v_perm_b32 v49, v116, v116, v81
    v_perm_b32 v50, v116, v116, v82
    v_perm_b32 v51, v116, v116, v83
    v_perm_b32 v52, v116, v116, v84
    v_perm_b32 v53, v116, v116, v85
    v_perm_b32 v54, v116, v116, v86
    v_perm_b32 v55, v116, v116, v87
    v_perm_b32 v56, v117, v117, v80
    v_perm_b32 v57, v117, v117, v81
    v_perm_b32 v58, v117, v117, v82
    v_perm_b32 v59, v117, v117, v83
    s_waitcnt vmcnt(5)
    v_mfma_f32_16x16x32_bf16 v[64:67], v[60:63], v[220:223], v[64:67]
    v_mfma_f32_16x16x32_bf16 v[64:67], v[48:51], v[224:227], v[64:67]
    v_mfma_f32_16x16x32_bf16 v[64:67], v[52:55], v[228:231], v[64:67]
    v_mfma_f32_16x16x32_bf16 v[64:67], v[56:59], v[232:235], v[64:67]
    v_perm_b32 v60, v117, v117, v84
    v_perm_b32 v61, v117, v117, v85
    v_perm_b32 v62, v117, v117, v86
    v_perm_b32 v63, v117, v117, v87
    s_waitcnt vmcnt(4)
    s_nop 0
    v_mfma_f32_16x16x32_bf16 v[64:67], v[60:63], v[236:239], v[64:67]
    v_perm_b32 v48, v118, v118, v80
    v_perm_b32 v49, v118, v118, v81
    v_perm_b32 v50, v118, v118, v82
    v_perm_b32 v51, v118, v118, v83
    s_waitcnt vmcnt(3)
    s_nop 0
    v_mfma_f32_16x16x32_bf16 v[64:67], v[48:51], v[240:243], v[64:67]
    v_perm_b32 v52, v118, v118, v84
    v_perm_b32 v53, v118, v118, v85
    v_perm_b32 v54, v118, v118, v86
    v_perm_b32 v55, v118, v118, v87
    s_waitcnt vmcnt(2)
    s_nop 0
    v_mfma_f32_16x16x32_bf16 v[64:67], v[52:55], v[244:247], v[64:67]
    v_perm_b32 v56, v119, v119, v80
    v_perm_b32 v57, v119, v119, v81
    v_perm_b32 v58, v119, v119, v82
    v_perm_b32 v59, v119, v119, v83
    s_waitcnt vmcnt(1)
    s_nop 0
    v_mfma_f32_16x16x32_bf16 v[64:67], v[56:59], v[248:251], v[64:67]
    v_perm_b32 v60, v119, v119, v84
    v_perm_b32 v61, v119, v119, v85
    v_perm_b32 v62, v119, v119, v86
    v_perm_b32 v63, v119, v119, v87
    s_waitcnt vmcnt(0)
    s_nop 0
    v_mfma_f32_16x16x32_bf16 v[64:67], v[60:63], v[252:255], v[64:67]
L_tj:
    s_nop 7
    v_mul_f32 v64, v64, v9
    v_mul_f32 v65, v65, v9
    v_mul_f32 v66, v66, v9
    v_mul_f32 v67, v67, v9
    ds_write_b128 v15, v[64:67]
    s_cmp_lt_u32 s2, 208
    s_cbranch_scc1 L_t9
    buffer_load_dwordx4 v123, s[44:47], s72 offen nt lds
L_t9:
    s_waitcnt lgkmcnt(0)
    s_barrier
    s_cmp_lg_u32 s3, 0
    s_cbranch_scc1 L_sd
    ds_read_b128 v[28:31], v6 offset:0
    ds_read_b128 v[32:35], v6 offset:1024
    ds_read_b128 v[36:39], v6 offset:2048
    ds_read_b128 v[40:43], v6 offset:3072
    s_waitcnt lgkmcnt(2)
    v_add_f32 v28, v28, v32
    v_add_f32 v29, v29, v33
    v_add_f32 v30, v30, v34
    v_add_f32 v31, v31, v35
    s_waitcnt lgkmcnt(1)
    v_add_f32 v28, v28, v36
    v_add_f32 v29, v29, v37
    v_add_f32 v30, v30, v38
    v_add_f32 v31, v31, v39
    s_waitcnt lgkmcnt(0)
    v_add_f32 v28, v28, v40
    v_add_f32 v29, v29, v41
    v_add_f32 v30, v30, v42
    v_add_f32 v31, v31, v43
    v_cvt_pk_bf16_f32 v28, v28, v29
    v_cvt_pk_bf16_f32 v29, v30, v31
    v_min_u32 v28, -2, v28
    v_min_u32 v29, -2, v29
    s_cmp_eq_u32 s13, 2
    s_cbranch_scc0 L_st124
    buffer_store_dwordx2 v[28:29], v4, s[56:59], s63 offen
    s_mov_b32 exec_lo, 0xffff
    s_mov_b32 exec_hi, 0xffff
    buffer_store_dword v27, v5, s[56:59], s63 offen offset:512
    s_branch L_st124_d
L_st124:
    buffer_store_dwordx2 v[28:29], v4, s[56:59], s63 offen sc1
    s_mov_b32 exec_lo, 0xffff
    s_mov_b32 exec_hi, 0xffff
    buffer_store_dword v27, v5, s[56:59], s63 offen offset:512 sc1
L_st124_d:
    ds_write_b32 v8, v27
    s_mov_b64 exec, -1
    ds_write_b64 v7, v[28:29]
L_sd:
    s_waitcnt vmcnt(0) lgkmcnt(0)
    s_barrier
    s_barrier
    s_branch L_fin
L_aux:
    s_sub_u32 s4, s3, 4
    v_mul_u32_u24 v1, 36, v0
    s_mul_i32 s5, s4, 2304
    v_lshlrev_b32 v2, 4, v0
    v_mov_b32 v8, 145472
    v_mov_b32 v4, 0
    v_mov_b32 v5, 0
    v_mov_b32 v6, 0
    v_mov_b32 v7, 0
    ds_write_b128 v8, v[4:7]
    ds_write_b128 v8, v[4:7] offset:16
    ds_write_b128 v8, v[4:7] offset:32
    s_movk_i32 s42, 9216
    s_mov_b32 s43, 0x20000
    s_waitcnt lgkmcnt(0)
    s_load_dword s14, s[38:39], 0
    s_mov_b64 s[40:41], s[16:17]
    buffer_load_dwordx3 v[16:18], v1, s[40:43], s5 offen offset:0
    buffer_load_dwordx3 v[20:22], v1, s[40:43], s5 offen offset:12
    buffer_load_dwordx3 v[24:26], v1, s[40:43], s5 offen offset:24
    s_barrier
    s_mov_b32 s56, s38
    s_mov_b32 s57, s39
    s_mov_b32 s58, 1245184
    s_mov_b32 s59, 0x20000
    s_add_u32 s13, s79, 64
    s_bitcmp1_b32 s2, 3
    s_cselect_b32 s60, 72, 0
    s_add_u32 s13, s13, s60
    s_cmp_ge_u32 s2, 144
    s_cselect_b32 s13, s10, s13
    s_lshl_b32 s13, s13, 11
    s_add_u32 s13, s13, 4096
    s_getreg_b32 s78, hwreg(HW_REG_XCC_ID, 0, 4)
    s_lshl_b32 s78, s78, 16
    s_and_b32 s77, s2, 7
    s_lshl_b32 s77, s77, 7
    s_add_u32 s77, s77, 1024
    s_mov_b32 s68, 0xffff0000
    s_mov_b32 s69, 0x3ae38e39
    s_add_u32 s5, s5, 131072
    v_add_u32 v1, s5, v1
    v_lshrrev_b32 v10, 4, v0
    v_and_b32 v11, 15, v0
    v_bfe_u32 v8, v0, 2, 2
    v_lshl_add_u32 v12, v10, 3, v8
    v_lshlrev_b32 v12, 7, v12
    v_and_b32 v9, 3, v0
    v_lshl_add_u32 v12, v9, 3, v12
    v_lshrrev_b32 v13, 1, v8
    v_and_b32 v8, 1, v10
    v_lshl_or_b32 v13, v8, 1, v13
    v_lshl_add_u32 v12, v13, 5, v12
    s_lshl_b32 s60, s4, 5
    v_xor_b32 v3, s60, v12
    v_add_u32 v4, 0x10000, v3
    v_and_b32 v14, 7, v0
    v_bfe_u32 v15, v0, 2, 3
    v_lshl_add_u32 v15, v9, 4, v15
    v_lshlrev_b32 v15, 2, v15
    v_mul_u32_u24 v5, 1152, v14
    v_lshrrev_b32 v8, 3, v11
    v_mul_u32_u24 v8, 576, v8
    v_lshl_add_u32 v8, v10, 4, v8
    v_add_u32 v5, v5, v8
    v_add_u32 v5, 131072, v5
    s_mov_b32 s71, 0x07060302
    v_and_b32 v57, 31, v0
    v_lshlrev_b32 v57, 2, v57
    s_waitcnt lgkmcnt(0)
    s_add_u32 s14, s14, 1
    s_and_b32 s15, s14, 0xffff
    s_and_b32 s6, s14, 0xff
    s_andn2_b32 s60, s14, 0xf0000
    s_or_b32 s78, s78, s60
    s_cmp_lg_u32 s4, 0
    s_cbranch_scc1 L_a1
    s_lshr_b32 s60, s2, 3
    s_lshl_b32 s60, s60, 2
    s_add_u32 s60, s60, s77
    v_mov_b32 v8, s78
    s_mov_b64 exec, 1
    buffer_store_dword v8, v57, s[56:59], s60 offen
    s_mov_b64 exec, -1
    s_waitcnt vmcnt(1)
    s_branch L_a2
L_a1:
    s_waitcnt vmcnt(0)
L_a2:
    v_lshlrev_b32 v28, 16, v16
    v_and_b32 v29, s68, v16
    v_lshlrev_b32 v30, 16, v17
    v_and_b32 v31, s68, v17
    v_lshlrev_b32 v32, 16, v18
    v_and_b32 v33, s68, v18
    v_lshlrev_b32 v34, 16, v20
    v_and_b32 v35, s68, v20
    v_lshlrev_b32 v36, 16, v21
    v_and_b32 v37, s68, v21
    v_lshlrev_b32 v38, 16, v22
    v_and_b32 v39, s68, v22
    v_lshlrev_b32 v40, 16, v24
    v_and_b32 v41, s68, v24
    v_lshlrev_b32 v42, 16, v25
    v_and_b32 v43, s68, v25
    v_lshlrev_b32 v44, 16, v26
    v_and_b32 v45, s68, v26
    v_pk_add_f32 v[46:47], v[28:29], v[30:31]
    v_pk_add_f32 v[46:47], v[46:47], v[32:33]
    v_pk_add_f32 v[46:47], v[46:47], v[34:35]
    v_pk_add_f32 v[46:47], v[46:47], v[36:37]
    v_pk_add_f32 v[46:47], v[46:47], v[38:39]
    v_pk_add_f32 v[46:47], v[46:47], v[40:41]
    v_pk_add_f32 v[46:47], v[46:47], v[42:43]
    v_pk_add_f32 v[46:47], v[46:47], v[44:45]
    v_add_f32 v46, v46, v47
    s_nop 1
    v_add_f32_dpp v46, v46, v46 row_ror:8 row_mask:0xf bank_mask:0xf
    s_nop 1
    v_add_f32_dpp v46, v46, v46 row_ror:4 row_mask:0xf bank_mask:0xf
    s_nop 1
    v_add_f32_dpp v46, v46, v46 row_ror:2 row_mask:0xf bank_mask:0xf
    s_nop 1
    v_add_f32_dpp v46, v46, v46 row_ror:1 row_mask:0xf bank_mask:0xf
    v_mov_b32 v47, v46
    s_nop 1
    v_permlane16_swap_b32 v46, v47
    v_add_f32 v46, v46, v47
    v_mul_f32 v48, s69, v46
    v_sub_f32 v50, 0, v48
    v_sub_f32 v51, 0, v48
    v_pk_add_f32 v[8:9], v[28:29], v[50:51]
    v_pk_mul_f32 v[46:47], v[8:9], v[8:9]
    v_pk_add_f32 v[8:9], v[30:31], v[50:51]
    v_pk_fma_f32 v[46:47], v[8:9], v[8:9], v[46:47]
    v_pk_add_f32 v[8:9], v[32:33], v[50:51]
    v_pk_fma_f32 v[46:47], v[8:9], v[8:9], v[46:47]
    v_pk_add_f32 v[8:9], v[34:35], v[50:51]
    v_pk_fma_f32 v[46:47], v[8:9], v[8:9], v[46:47]
    v_pk_add_f32 v[8:9], v[36:37], v[50:51]
    v_pk_fma_f32 v[46:47], v[8:9], v[8:9], v[46:47]
    v_pk_add_f32 v[8:9], v[38:39], v[50:51]
    v_pk_fma_f32 v[46:47], v[8:9], v[8:9], v[46:47]
    v_pk_add_f32 v[8:9], v[40:41], v[50:51]
    v_pk_fma_f32 v[46:47], v[8:9], v[8:9], v[46:47]
    v_pk_add_f32 v[8:9], v[42:43], v[50:51]
    v_pk_fma_f32 v[46:47], v[8:9], v[8:9], v[46:47]
    v_pk_add_f32 v[8:9], v[44:45], v[50:51]
    v_pk_fma_f32 v[46:47], v[8:9], v[8:9], v[46:47]
    v_add_f32 v46, v46, v47
    s_nop 1
    v_add_f32_dpp v46, v46, v46 row_ror:8 row_mask:0xf bank_mask:0xf
    s_nop 1
    v_add_f32_dpp v46, v46, v46 row_ror:4 row_mask:0xf bank_mask:0xf
    s_nop 1
    v_add_f32_dpp v46, v46, v46 row_ror:2 row_mask:0xf bank_mask:0xf
    s_nop 1
    v_add_f32_dpp v46, v46, v46 row_ror:1 row_mask:0xf bank_mask:0xf
    v_mov_b32 v47, v46
    s_nop 1
    v_permlane16_swap_b32 v46, v47
    v_add_f32 v46, v46, v47
    v_mul_f32 v46, s69, v46
    v_cvt_pk_bf16_f32 v46, v46, v46
    v_lshlrev_b32 v46, 16, v46
    v_add_f32 v46, 0x3727c5ac, v46
    v_cvt_pk_bf16_f32 v46, v46, v46
    v_lshlrev_b32 v46, 16, v46
    v_sqrt_f32 v46, v46
    s_nop 0
    v_cvt_pk_bf16_f32 v46, v46, v46
    v_lshlrev_b32 v46, 16, v46
    v_rcp_f32 v46, v46
    v_cvt_pk_bf16_f32 v50, v50, v50
    v_lshlrev_b32 v50, 16, v50
    v_mov_b32 v51, v50
    v_mov_b32 v47, v46
    v_pk_add_f32 v[8:9], v[28:29], v[50:51]
    v_cvt_pk_bf16_f32 v9, v8, v9
    v_lshlrev_b32 v8, 16, v9
    v_and_b32 v9, s68, v9
    v_pk_mul_f32 v[8:9], v[8:9], v[46:47]
    v_cvt_pk_bf16_f32 v16, v8, v9
    v_pk_add_f32 v[8:9], v[30:31], v[50:51]
    v_cvt_pk_bf16_f32 v9, v8, v9
    v_lshlrev_b32 v8, 16, v9
    v_and_b32 v9, s68, v9
    v_pk_mul_f32 v[8:9], v[8:9], v[46:47]
    v_cvt_pk_bf16_f32 v17, v8, v9
    v_pk_add_f32 v[8:9], v[32:33], v[50:51]
    v_cvt_pk_bf16_f32 v9, v8, v9
    v_lshlrev_b32 v8, 16, v9
    v_and_b32 v9, s68, v9
    v_pk_mul_f32 v[8:9], v[8:9], v[46:47]
    v_cvt_pk_bf16_f32 v18, v8, v9
    v_pk_add_f32 v[8:9], v[34:35], v[50:51]
    v_cvt_pk_bf16_f32 v9, v8, v9
    v_lshlrev_b32 v8, 16, v9
    v_and_b32 v9, s68, v9
    v_pk_mul_f32 v[8:9], v[8:9], v[46:47]
    v_cvt_pk_bf16_f32 v20, v8, v9
    v_pk_add_f32 v[8:9], v[36:37], v[50:51]
    v_cvt_pk_bf16_f32 v9, v8, v9
    v_lshlrev_b32 v8, 16, v9
    v_and_b32 v9, s68, v9
    v_pk_mul_f32 v[8:9], v[8:9], v[46:47]
    v_cvt_pk_bf16_f32 v21, v8, v9
    v_pk_add_f32 v[8:9], v[38:39], v[50:51]
    v_cvt_pk_bf16_f32 v9, v8, v9
    v_lshlrev_b32 v8, 16, v9
    v_and_b32 v9, s68, v9
    v_pk_mul_f32 v[8:9], v[8:9], v[46:47]
    v_cvt_pk_bf16_f32 v22, v8, v9
    v_pk_add_f32 v[8:9], v[40:41], v[50:51]
    v_cvt_pk_bf16_f32 v9, v8, v9
    v_lshlrev_b32 v8, 16, v9
    v_and_b32 v9, s68, v9
    v_pk_mul_f32 v[8:9], v[8:9], v[46:47]
    v_cvt_pk_bf16_f32 v24, v8, v9
    v_pk_add_f32 v[8:9], v[42:43], v[50:51]
    v_cvt_pk_bf16_f32 v9, v8, v9
    v_lshlrev_b32 v8, 16, v9
    v_and_b32 v9, s68, v9
    v_pk_mul_f32 v[8:9], v[8:9], v[46:47]
    v_cvt_pk_bf16_f32 v25, v8, v9
    v_pk_add_f32 v[8:9], v[44:45], v[50:51]
    v_cvt_pk_bf16_f32 v9, v8, v9
    v_lshlrev_b32 v8, 16, v9
    v_and_b32 v9, s68, v9
    v_pk_mul_f32 v[8:9], v[8:9], v[46:47]
    v_cvt_pk_bf16_f32 v26, v8, v9
    ds_write2_b32 v1, v16, v17 offset0:0 offset1:1
    ds_write2_b32 v1, v18, v20 offset0:2 offset1:3
    ds_write2_b32 v1, v21, v22 offset0:4 offset1:5
    ds_write2_b32 v1, v24, v25 offset0:6 offset1:7
    ds_write_b32 v1, v26 offset:32
    v_mov_b32 v208, -1
    v_mov_b32 v209, -1
    v_mov_b32 v210, -1
    v_mov_b32 v211, -1
    s_lshl_b32 s61, s10, 2
    s_add_u32 s61, s61, s4
    s_mul_i32 s61, s61, 640
    s_add_u32 s61, s61, 458752
    v_mov_b32 v1, v57
    s_waitcnt lgkmcnt(0)
    s_mov_b64 exec, 1
    v_mov_b32 v8, 145480
    v_mov_b32 v9, 1
    ds_add_u32 v8, v9
    s_mov_b64 exec, -1
    s_mov_b32 s70, 2
    s_cmp_ge_u32 s2, 208
    s_cbranch_scc1 L_a4
L_xid:
    buffer_load_dword v212, v1, s[56:59], s77 offen sc1
    s_waitcnt vmcnt(0)
    v_cmp_ne_u32 vcc, s78, v212
    s_cmp_eq_u32 vcc_lo, 0
    s_cselect_b32 s7, 2, 1
    s_cmp_eq_u32 s7, 2
    s_cbranch_scc1 L_xidd
    s_sub_u32 s70, s70, 1
    s_cbranch_scc0 L_xid
L_xidd:
    s_cmp_lt_u32 s2, 144
    s_cbranch_scc1 L_a4
    s_mov_b32 exec_hi, 0xff
    s_cmp_eq_u32 s7, 2
    s_cbranch_scc0 L_st125
    buffer_store_dwordx4 v[208:211], v2, s[56:59], s61 offen
    s_branch L_st125_d
L_st125:
    buffer_store_dwordx4 v[208:211], v2, s[56:59], s61 offen sc1
L_st125_d:
L_a4:
    s_mov_b64 exec, 1
    s_mov_b32 s70, 16000000
L_spin126:
    ds_read_b32 v9, v8
    s_waitcnt lgkmcnt(0)
    v_readfirstlane_b32 s60, v9
    s_cmp_ge_u32 s60, 8
    s_cbranch_scc1 L_spin126_d
    s_sub_u32 s70, s70, 1
    s_cbranch_scc1 L_spin126_d
    s_sleep 2
    s_branch L_spin126
L_spin126_d:
    s_mov_b64 exec, -1
    ds_read_b128 v[16:19], v5 offset:0
    ds_read_b128 v[20:23], v5 offset:64
    ds_read_b128 v[24:27], v5 offset:128
    ds_read_b128 v[28:31], v5 offset:192
    ds_read_b128 v[32:35], v5 offset:256
    ds_read_b128 v[36:39], v5 offset:320
    ds_read_b128 v[40:43], v5 offset:384
    ds_read_b128 v[44:47], v5 offset:448
    ds_read_b128 v[48:51], v5 offset:512
    ds_read_b64_tr_b16 v[52:53], v3 offset:0
    ds_read_b64_tr_b16 v[54:55], v3 offset:512
    ds_read_b64_tr_b16 v[56:57], v3 offset:4096
    ds_read_b64_tr_b16 v[58:59], v3 offset:4608
    ds_read_b64_tr_b16 v[60:61], v3 offset:8192
    ds_read_b64_tr_b16 v[62:63], v3 offset:8704
    ds_read_b64_tr_b16 v[64:65], v3 offset:12288
    ds_read_b64_tr_b16 v[66:67], v3 offset:12800
    ds_read_b64_tr_b16 v[68:69], v3 offset:16384
    ds_read_b64_tr_b16 v[70:71], v3 offset:16896
    ds_read_b64_tr_b16 v[72:73], v3 offset:20480
    ds_read_b64_tr_b16 v[74:75], v3 offset:20992
    ds_read_b64_tr_b16 v[76:77], v3 offset:24576
    ds_read_b64_tr_b16 v[78:79], v3 offset:25088
    ds_read_b64_tr_b16 v[80:81], v3 offset:28672
    ds_read_b64_tr_b16 v[82:83], v3 offset:29184
    ds_read_b64_tr_b16 v[84:85], v3 offset:32768
    ds_read_b64_tr_b16 v[86:87], v3 offset:33280
    ds_read_b64_tr_b16 v[88:89], v3 offset:36864
    ds_read_b64_tr_b16 v[90:91], v3 offset:37376
    ds_read_b64_tr_b16 v[92:93], v3 offset:40960
    ds_read_b64_tr_b16 v[94:95], v3 offset:41472
    ds_read_b64_tr_b16 v[96:97], v3 offset:45056
    ds_read_b64_tr_b16 v[98:99], v3 offset:45568
    ds_read_b64_tr_b16 v[100:101], v3 offset:49152
    ds_read_b64_tr_b16 v[102:103], v3 offset:49664
    ds_read_b64_tr_b16 v[104:105], v3 offset:53248
    ds_read_b64_tr_b16 v[106:107], v3 offset:53760
    ds_read_b64_tr_b16 v[108:109], v3 offset:57344
    ds_read_b64_tr_b16 v[110:111], v3 offset:57856
    ds_read_b64_tr_b16 v[112:113], v3 offset:61440
    ds_read_b64_tr_b16 v[114:115], v3 offset:61952
    ds_read_b64_tr_b16 v[116:117], v4 offset:0
    ds_read_b64_tr_b16 v[118:119], v4 offset:512
    ds_read_b64_tr_b16 v[120:121], v4 offset:4096
    ds_read_b64_tr_b16 v[122:123], v4 offset:4608
    s_lshl_b32 s60, s4, 9
    s_add_u32 s60, s60, s13
    v_mov_b32 v7, s68
    v_mov_b32 v232, 145488
    s_lshr_b32 s61, s2, 3
    s_lshl_b32 s61, s61, 2
    v_mov_b32 v235, s61
    s_add_u32 s76, s77, 1024
    s_waitcnt lgkmcnt(0)
    s_mov_b64 exec, 1
    v_mov_b32 v8, 145484
    v_mov_b32 v9, 1
    ds_add_u32 v8, v9
    s_mov_b64 exec, -1
    s_cmp_ge_u32 s2, 208
    s_cbranch_scc1 L_aq
    v_mfma_f32_16x16x32_bf16 v[192:195], v[52:55], v[16:19], 0
    v_mfma_f32_16x16x32_bf16 v[196:199], v[88:91], v[16:19], 0
    v_mfma_f32_16x16x32_bf16 v[192:195], v[56:59], v[20:23], v[192:195]
    v_mfma_f32_16x16x32_bf16 v[196:199], v[92:95], v[20:23], v[196:199]
    v_mfma_f32_16x16x32_bf16 v[192:195], v[60:63], v[24:27], v[192:195]
    v_mfma_f32_16x16x32_bf16 v[196:199], v[96:99], v[24:27], v[196:199]
    v_mfma_f32_16x16x32_bf16 v[192:195], v[64:67], v[28:31], v[192:195]
    v_mfma_f32_16x16x32_bf16 v[196:199], v[100:103], v[28:31], v[196:199]
    v_mfma_f32_16x16x32_bf16 v[192:195], v[68:71], v[32:35], v[192:195]
    v_mfma_f32_16x16x32_bf16 v[196:199], v[104:107], v[32:35], v[196:199]
    v_mfma_f32_16x16x32_bf16 v[192:195], v[72:75], v[36:39], v[192:195]
    v_mfma_f32_16x16x32_bf16 v[196:199], v[108:111], v[36:39], v[196:199]
    v_mfma_f32_16x16x32_bf16 v[192:195], v[76:79], v[40:43], v[192:195]
    v_mfma_f32_16x16x32_bf16 v[196:199], v[112:115], v[40:43], v[196:199]
    v_mfma_f32_16x16x32_bf16 v[192:195], v[80:83], v[44:47], v[192:195]
    v_mfma_f32_16x16x32_bf16 v[196:199], v[116:119], v[44:47], v[196:199]
    v_mfma_f32_16x16x32_bf16 v[192:195], v[84:87], v[48:51], v[192:195]
    v_mfma_f32_16x16x32_bf16 v[196:199], v[120:123], v[48:51], v[196:199]
    s_nop 7
    v_add_f32_dpp v192, v196, v192 row_ror:8 row_mask:0xf bank_mask:0xf
    v_add_f32_dpp v193, v197, v193 row_ror:8 row_mask:0xf bank_mask:0xf
    v_add_f32_dpp v194, v198, v194 row_ror:8 row_mask:0xf bank_mask:0xf
    v_add_f32_dpp v195, v199, v195 row_ror:8 row_mask:0xf bank_mask:0xf
    v_cvt_pk_bf16_f32 v8, v192, v193
    v_cvt_pk_bf16_f32 v9, v194, v195
    ds_bpermute_b32 v8, v15, v8
    ds_bpermute_b32 v9, v15, v9
    s_waitcnt lgkmcnt(0)
    v_lshl_or_b32 v16, v8, 16, s15
    v_and_or_b32 v17, v8, v7, s15
    v_lshl_or_b32 v18, v9, 16, s15
    v_and_or_b32 v19, v9, v7, s15
    s_waitcnt vmcnt(0)
    s_mov_b32 exec_hi, 0
    s_cmp_eq_u32 s7, 2
    s_cbranch_scc0 L_st127
    buffer_store_dwordx4 v[16:19], v2, s[56:59], s60 offen
    s_branch L_st127_d
L_st127:
    buffer_store_dwordx4 v[16:19], v2, s[56:59], s60 offen sc1
L_st127_d:
    s_mov_b32 exec_hi, -1
    s_lshl_b32 s60, s4, 8
    s_add_u32 s60, s60, s2
    s_cmp_lg_u32 s60, 400
    s_cbranch_scc1 L_aq
    v_lshlrev_b32 v8, 13, v0
    v_mov_b32 v9, 1
    s_mov_b32 s60, 442368
    s_mov_b64 exec, 3
    buffer_store_dword v9, v8, s[56:59], s60 offen sc1
    s_mov_b64 exec, -1
    s_mov_b32 s62, 0
    s_mov_b32 s70, 2
    s_waitcnt vmcnt(0)
L_race:
    s_mov_b64 s[60:61], 0
    s_load_dword s60, s[38:39], 442368 glc
    s_load_dword s61, s[38:39], 450560 glc
    s_waitcnt lgkmcnt(1)
    s_add_u32 s62, s62, s60
    s_sub_u32 s62, s62, s61
    s_waitcnt lgkmcnt(0)
    s_mov_b64 s[60:61], 0
    s_load_dword s61, s[38:39], 450560 glc
    s_load_dword s60, s[38:39], 442368 glc
    s_waitcnt lgkmcnt(1)
    s_add_u32 s62, s62, s60
    s_sub_u32 s62, s62, s61
    s_waitcnt lgkmcnt(0)
    s_sub_u32 s70, s70, 1
    s_cbranch_scc0 L_race
    s_cmp_lt_i32 s62, 0
    s_cselect_b32 s60, 0x10000, 0
    s_or_b32 s60, s60, s15
    v_mov_b32 v8, s60
    v_mov_b32 v9, s14
    s_mov_b64 exec, 1
    buffer_store_dwordx2 v[8:9], v2, s[56:59], 0 offen offset:512 sc1
    s_mov_b64 exec, -1
L_aq:
    s_cmp_lg_u32 s4, 2
    s_cbranch_scc1 L_ctl128_d
    s_mov_b32 s70, 2000000
L_ctl128:
    ds_read_b128 v[236:239], v232
    s_waitcnt lgkmcnt(0)
    v_add3_u32 v233, v236, v237, v238
    v_add_u32 v233, v233, v239
    s_nop 0
    v_readfirstlane_b32 s66, v233
    v_lshl_or_b32 v233, v233, 16, s15
    s_mov_b64 exec, 1
    buffer_store_dword v233, v235, s[56:59], s76 offen
    s_mov_b64 exec, -1
    s_cmp_ge_u32 s66, 56
    s_cbranch_scc1 L_ctl128_d
    buffer_load_dword v236, v1, s[56:59], s76 offen sc1
    v_add_u32 v233, 0x10000, v233
    s_waitcnt vmcnt(0)
    v_sub_u32 v236, v236, v233
    v_and_b32 v236, 0x8000ffff, v236
    v_cmp_eq_u32 vcc, 0, v236
    s_bcnt1_i32_b32 s66, vcc_lo
    s_cmp_ge_u32 s66, 16
    s_cselect_b32 s66, 1, 0
    v_mov_b32 v236, s66
    ds_write_b32 v232, v236 offset:16
    s_sub_u32 s70, s70, 1
    s_cbranch_scc0 L_ctl128
L_ctl128_d:
    s_mov_b32 s70, 16000000
L_spin129:
    ds_read_b128 v[236:239], v232
    s_waitcnt lgkmcnt(0)
    v_add3_u32 v233, v236, v237, v238
    v_add_u32 v233, v233, v239
    s_nop 0
    v_readfirstlane_b32 s60, v233
    s_cmp_ge_u32 s60, 56
    s_cbranch_scc1 L_spin129_d
    s_sub_u32 s70, s70, 1
    s_cbranch_scc1 L_spin129_d
    s_sleep 8
    s_branch L_spin129
L_spin129_d:
    s_mov_b64 exec, -1
    s_cmp_lg_u32 s4, 3
    s_cbranch_scc1 L_a3
    s_lshr_b32 s60, s9, 1
    s_lshl_b32 s60, s60, 6
    s_lshl_b32 s61, s8, 13
    s_add_u32 s60, s60, s61
    s_add_u32 s60, s60, 4096
    v_lshrrev_b32 v6, 2, v0
    v_lshlrev_b32 v6, 9, v6
    v_and_b32 v7, 3, v0
    v_lshl_add_u32 v6, v7, 4, v6
    buffer_load_dword v24, v1, s[56:59], s77 offen sc1
    s_mov_b32 s70, 2000000
L_poll130:
    buffer_load_dwordx4 v[20:23], v6, s[56:59], s60 offen sc1 nt
L_poll130_w:
    s_waitcnt vmcnt(0)
    v_xor_b32 v7, s15, v20
    v_bitop3_b32 v7, v21, v7, s15 bitop3:0xde
    v_bitop3_b32 v7, v22, v7, s15 bitop3:0xde
    v_bitop3_b32 v7, v23, v7, s15 bitop3:0xde
    v_and_b32 v7, 0xffff, v7
    v_cmp_ne_u32 vcc, 0, v7
    s_and_b64 exec, exec, vcc
    s_cbranch_scc0 L_poll130_d
    s_sub_u32 s70, s70, 1
    s_cbranch_scc1 L_poll130_d
    s_sleep 4
    s_branch L_poll130
L_poll130_d:
    s_mov_b64 exec, -1
    v_cmp_ne_u32 vcc, s78, v24
    s_cmp_eq_u32 vcc_lo, 0
    s_cselect_b32 s7, 2, 1
    v_perm_b32 v8, v21, v20, s71
    v_perm_b32 v9, v23, v22, s71
    v_lshlrev_b32 v6, 3, v0
    v_add_u32 v6, 140288, v6
    ds_write_b64 v6, v[8:9]
    v_mov_b32 v6, 145476
    v_mov_b32 v7, s7
    s_waitcnt lgkmcnt(0)
    ds_write_b32 v6, v7
L_a3:
    v_mul_u32_u24 v4, 31744, v10
    v_add_u32 v4, v4, v3
    v_mov_b32 v12, 0xffffff00
    s_lshl_b32 s65, s8, 7
    s_add_u32 s65, s65, 655360
    s_cmp_lt_u32 s2, 144
    s_cbranch_scc1 L_aO
    s_cmp_ge_u32 s2, 208
    s_cbranch_scc1 L_aD
    s_cmp_lg_u32 s4, 2
    s_cbranch_scc1 L_ctl131_d
    s_mov_b32 s70, 2000000
L_ctl131:
    ds_read_b128 v[236:239], v232
    s_waitcnt lgkmcnt(0)
    v_add3_u32 v233, v236, v237, v238
    v_add_u32 v233, v233, v239
    s_nop 0
    v_readfirstlane_b32 s66, v233
    v_lshl_or_b32 v233, v233, 16, s15
    s_mov_b64 exec, 1
    buffer_store_dword v233, v235, s[56:59], s76 offen
    s_mov_b64 exec, -1
    s_cmp_ge_u32 s66, 136
    s_cbranch_scc1 L_ctl131_d
    buffer_load_dword v236, v1, s[56:59], s76 offen sc1
    v_add_u32 v233, 0x10000, v233
    s_waitcnt vmcnt(0)
    v_sub_u32 v236, v236, v233
    v_and_b32 v236, 0x8000ffff, v236
    v_cmp_eq_u32 vcc, 0, v236
    s_bcnt1_i32_b32 s66, vcc_lo
    s_cmp_ge_u32 s66, 16
    s_cselect_b32 s66, 1, 0
    v_mov_b32 v236, s66
    ds_write_b32 v232, v236 offset:16
    s_sub_u32 s70, s70, 1
    s_cbranch_scc0 L_ctl131
L_ctl131_d:
    s_branch L_fin
L_aD:
    s_cmp_lg_u32 s4, 2
    s_cbranch_scc1 L_ctl132_d
    s_mov_b32 s70, 2000000
L_ctl132:
    ds_read_b128 v[236:239], v232
    s_waitcnt lgkmcnt(0)
    v_add3_u32 v233, v236, v237, v238
    v_add_u32 v233, v233, v239
    s_nop 0
    v_readfirstlane_b32 s66, v233
    v_lshl_or_b32 v233, v233, 16, s15
    s_mov_b64 exec, 1
    buffer_store_dword v233, v235, s[56:59], s76 offen
    s_mov_b64 exec, -1
    s_cmp_ge_u32 s66, 64
    s_cbranch_scc1 L_ctl132_d
    buffer_load_dword v236, v1, s[56:59], s76 offen sc1
    v_add_u32 v233, 0x10000, v233
    s_waitcnt vmcnt(0)
    v_sub_u32 v236, v236, v233
    v_and_b32 v236, 0x8000ffff, v236
    v_cmp_eq_u32 vcc, 0, v236
    s_bcnt1_i32_b32 s66, vcc_lo
    s_cmp_ge_u32 s66, 16
    s_cselect_b32 s66, 1, 0
    v_mov_b32 v236, s66
    ds_write_b32 v232, v236 offset:16
    s_sub_u32 s70, s70, 1
    s_cbranch_scc0 L_ctl132
L_ctl132_d:
    s_mov_b32 s70, 16000000
L_spin133:
    ds_read_b128 v[236:239], v232
    s_waitcnt lgkmcnt(0)
    v_add3_u32 v233, v236, v237, v238
    v_add_u32 v233, v233, v239
    s_nop 0
    v_readfirstlane_b32 s60, v233
    s_cmp_ge_u32 s60, 64
    s_cbranch_scc1 L_spin133_d
    s_sub_u32 s70, s70, 1
    s_cbranch_scc1 L_spin133_d
    s_sleep 8
    s_branch L_spin133
L_spin133_d:
    s_mov_b64 exec, -1
    s_mul_i32 s60, s11, 9216
    s_mul_i32 s61, s4, 2304
    s_add_u32 s60, s60, s61
    s_add_u32 s60, s60, 135168
    s_add_u32 s61, s60, 147456
    s_mov_b32 s72, -1
    s_mov_b32 s73, 0xffff
    s_mov_b64 exec, s[72:73]
    s_mov_b32 s70, 2000000
L_poll134:
    buffer_load_dwordx4 v[208:211], v2, s[56:59], s60 offen offset:0 sc1 nt
    buffer_load_dwordx4 v[212:215], v2, s[56:59], s60 offen offset:768 sc1 nt
    buffer_load_dwordx4 v[216:219], v2, s[56:59], s60 offen offset:1536 sc1 nt
    buffer_load_dwordx4 v[220:223], v2, s[56:59], s61 offen offset:0 sc1 nt
    buffer_load_dwordx4 v[224:227], v2, s[56:59], s61 offen offset:768 sc1 nt
    buffer_load_dwordx4 v[228:231], v2, s[56:59], s61 offen offset:1536 sc1 nt
L_poll134_w:
    s_waitcnt vmcnt(0)
    v_xor_b32 v8, s15, v208
    v_bitop3_b32 v8, v209, v8, s15 bitop3:0xde
    v_bitop3_b32 v8, v210, v8, s15 bitop3:0xde
    v_bitop3_b32 v8, v211, v8, s15 bitop3:0xde
    v_bitop3_b32 v8, v212, v8, s15 bitop3:0xde
    v_bitop3_b32 v8, v213, v8, s15 bitop3:0xde
    v_bitop3_b32 v8, v214, v8, s15 bitop3:0xde
    v_bitop3_b32 v8, v215, v8, s15 bitop3:0xde
    v_bitop3_b32 v8, v216, v8, s15 bitop3:0xde
    v_bitop3_b32 v8, v217, v8, s15 bitop3:0xde
    v_bitop3_b32 v8, v218, v8, s15 bitop3:0xde
    v_bitop3_b32 v8, v219, v8, s15 bitop3:0xde
    v_bitop3_b32 v8, v220, v8, s15 bitop3:0xde
    v_bitop3_b32 v8, v221, v8, s15 bitop3:0xde
    v_bitop3_b32 v8, v222, v8, s15 bitop3:0xde
    v_bitop3_b32 v8, v223, v8, s15 bitop3:0xde
    v_bitop3_b32 v8, v224, v8, s15 bitop3:0xde
    v_bitop3_b32 v8, v225, v8, s15 bitop3:0xde
    v_bitop3_b32 v8, v226, v8, s15 bitop3:0xde
    v_bitop3_b32 v8, v227, v8, s15 bitop3:0xde
    v_bitop3_b32 v8, v228, v8, s15 bitop3:0xde
    v_bitop3_b32 v8, v229, v8, s15 bitop3:0xde
    v_bitop3_b32 v8, v230, v8, s15 bitop3:0xde
    v_bitop3_b32 v8, v231, v8, s15 bitop3:0xde
    v_and_b32 v8, 0xffff, v8
    v_cmp_ne_u32 vcc, 0, v8
    s_and_b64 exec, exec, vcc
    s_cbranch_scc0 L_poll134_d
    s_sub_u32 s70, s70, 1
    s_cbranch_scc1 L_poll134_d
    s_sleep 8
    s_branch L_poll134
L_poll134_d:
    s_mov_b64 exec, s[72:73]
    v_mov_b32 v32, 0xc0135761
    v_mov_b32 v33, 0xbdd2d3e8
    s_mul_i32 s60, s4, 144
    v_and_b32 v34, s68, v208
    v_and_b32 v35, s68, v209
    v_mul_f32 v36, v34, v34
    v_mul_f32 v37, v35, v35
    v_fma_f32 v36, v36, v33, v32
    v_fma_f32 v37, v37, v33, v32
    v_mul_f32 v36, v36, v34
    v_mul_f32 v37, v37, v35
    v_exp_f32 v36, v36
    v_exp_f32 v37, v37
    v_and_b32 v38, s68, v220
    v_add_f32 v36, 1.0, v36
    v_add_f32 v37, 1.0, v37
    v_rcp_f32 v36, v36
    v_rcp_f32 v37, v37
    v_and_b32 v39, s68, v221
    v_mul_f32 v34, v34, v36
    v_mul_f32 v35, v35, v37
    v_cvt_pk_bf16_f32 v35, v34, v35
    v_lshlrev_b32 v34, 16, v35
    v_and_b32 v35, s68, v35
    v_mul_f32 v34, v34, v38
    v_mul_f32 v35, v35, v39
    v_cvt_pk_bf16_f32 v40, v34, v35
    v_and_b32 v34, s68, v210
    v_and_b32 v35, s68, v211
    v_mul_f32 v36, v34, v34
    v_mul_f32 v37, v35, v35
    v_fma_f32 v36, v36, v33, v32
    v_fma_f32 v37, v37, v33, v32
    v_mul_f32 v36, v36, v34
    v_mul_f32 v37, v37, v35
    v_exp_f32 v36, v36
    v_exp_f32 v37, v37
    v_and_b32 v38, s68, v222
    v_add_f32 v36, 1.0, v36
    v_add_f32 v37, 1.0, v37
    v_rcp_f32 v36, v36
    v_rcp_f32 v37, v37
    v_and_b32 v39, s68, v223
    v_mul_f32 v34, v34, v36
    v_mul_f32 v35, v35, v37
    v_cvt_pk_bf16_f32 v35, v34, v35
    v_lshlrev_b32 v34, 16, v35
    v_and_b32 v35, s68, v35
    v_mul_f32 v34, v34, v38
    v_mul_f32 v35, v35, v39
    v_cvt_pk_bf16_f32 v41, v34, v35
    v_and_b32 v34, s68, v212
    v_and_b32 v35, s68, v213
    v_mul_f32 v36, v34, v34
    v_mul_f32 v37, v35, v35
    v_fma_f32 v36, v36, v33, v32
    v_fma_f32 v37, v37, v33, v32
    v_mul_f32 v36, v36, v34
    v_mul_f32 v37, v37, v35
    v_exp_f32 v36, v36
    v_exp_f32 v37, v37
    v_and_b32 v38, s68, v224
    v_add_f32 v36, 1.0, v36
    v_add_f32 v37, 1.0, v37
    v_rcp_f32 v36, v36
    v_rcp_f32 v37, v37
    v_and_b32 v39, s68, v225
    v_mul_f32 v34, v34, v36
    v_mul_f32 v35, v35, v37
    v_cvt_pk_bf16_f32 v35, v34, v35
    v_lshlrev_b32 v34, 16, v35
    v_and_b32 v35, s68, v35
    v_mul_f32 v34, v34, v38
    v_mul_f32 v35, v35, v39
    v_cvt_pk_bf16_f32 v42, v34, v35
    v_and_b32 v34, s68, v214
    v_and_b32 v35, s68, v215
    v_mul_f32 v36, v34, v34
    v_mul_f32 v37, v35, v35
    v_fma_f32 v36, v36, v33, v32
    v_fma_f32 v37, v37, v33, v32
    v_mul_f32 v36, v36, v34
    v_mul_f32 v37, v37, v35
    v_exp_f32 v36, v36
    v_exp_f32 v37, v37
    v_and_b32 v38, s68, v226
    v_add_f32 v36, 1.0, v36
    v_add_f32 v37, 1.0, v37
    v_rcp_f32 v36, v36
    v_rcp_f32 v37, v37
    v_and_b32 v39, s68, v227
    v_mul_f32 v34, v34, v36
    v_mul_f32 v35, v35, v37
    v_cvt_pk_bf16_f32 v35, v34, v35
    v_lshlrev_b32 v34, 16, v35
    v_and_b32 v35, s68, v35
    v_mul_f32 v34, v34, v38
    v_mul_f32 v35, v35, v39
    v_cvt_pk_bf16_f32 v43, v34, v35
    v_and_b32 v34, s68, v216
    v_and_b32 v35, s68, v217
    v_mul_f32 v36, v34, v34
    v_mul_f32 v37, v35, v35
    v_fma_f32 v36, v36, v33, v32
    v_fma_f32 v37, v37, v33, v32
    v_mul_f32 v36, v36, v34
    v_mul_f32 v37, v37, v35
    v_exp_f32 v36, v36
    v_exp_f32 v37, v37
    v_and_b32 v38, s68, v228
    v_add_f32 v36, 1.0, v36
    v_add_f32 v37, 1.0, v37
    v_rcp_f32 v36, v36
    v_rcp_f32 v37, v37
    v_and_b32 v39, s68, v229
    v_mul_f32 v34, v34, v36
    v_mul_f32 v35, v35, v37
    v_cvt_pk_bf16_f32 v35, v34, v35
    v_lshlrev_b32 v34, 16, v35
    v_and_b32 v35, s68, v35
    v_mul_f32 v34, v34, v38
    v_mul_f32 v35, v35, v39
    v_cvt_pk_bf16_f32 v44, v34, v35
    v_and_b32 v34, s68, v218
    v_and_b32 v35, s68, v219
    v_mul_f32 v36, v34, v34
    v_mul_f32 v37, v35, v35
    v_fma_f32 v36, v36, v33, v32
    v_fma_f32 v37, v37, v33, v32
    v_mul_f32 v36, v36, v34
    v_mul_f32 v37, v37, v35
    v_exp_f32 v36, v36
    v_exp_f32 v37, v37
    v_and_b32 v38, s68, v230
    v_add_f32 v36, 1.0, v36
    v_add_f32 v37, 1.0, v37
    v_rcp_f32 v36, v36
    v_rcp_f32 v37, v37
    v_and_b32 v39, s68, v231
    v_mul_f32 v34, v34, v36
    v_mul_f32 v35, v35, v37
    v_cvt_pk_bf16_f32 v35, v34, v35
    v_lshlrev_b32 v34, 16, v35
    v_and_b32 v35, s68, v35
    v_mul_f32 v34, v34, v38
    v_mul_f32 v35, v35, v39
    v_cvt_pk_bf16_f32 v45, v34, v35
    v_add_u32 v34, s60, v0
    v_bfe_u32 v35, v34, 2, 3
    v_mul_u32_u24 v35, 576, v35
    v_and_b32 v36, 3, v34
    v_lshl_add_u32 v35, v36, 3, v35
    v_and_b32 v34, 0xffe0, v34
    v_add_u32 v35, v35, v34
    v_add_u32 v35, 140800, v35
    ds_write_b64 v35, v[40:41]
    s_add_u32 s60, s60, 48
    v_add_u32 v34, s60, v0
    v_bfe_u32 v35, v34, 2, 3
    v_mul_u32_u24 v35, 576, v35
    v_and_b32 v36, 3, v34
    v_lshl_add_u32 v35, v36, 3, v35
    v_and_b32 v34, 0xffe0, v34
    v_add_u32 v35, v35, v34
    v_add_u32 v35, 140800, v35
    ds_write_b64 v35, v[42:43]
    s_add_u32 s60, s60, 48
    v_add_u32 v34, s60, v0
    v_bfe_u32 v35, v34, 2, 3
    v_mul_u32_u24 v35, 576, v35
    v_and_b32 v36, 3, v34
    v_lshl_add_u32 v35, v36, 3, v35
    v_and_b32 v34, 0xffe0, v34
    v_add_u32 v35, v35, v34
    v_add_u32 v35, 140800, v35
    ds_write_b64 v35, v[44:45]
    s_add_u32 s60, s60, 48
    s_waitcnt lgkmcnt(0)
    s_mov_b64 exec, 1
    v_mov_b32 v8, 145472
    v_mov_b32 v9, 1
    ds_add_u32 v8, v9
    s_mov_b32 s70, 16000000
L_spin135:
    ds_read_b32 v9, v8
    s_waitcnt lgkmcnt(0)
    v_readfirstlane_b32 s60, v9
    s_cmp_ge_u32 s60, 4
    s_cbranch_scc1 L_spin135_d
    s_sub_u32 s70, s70, 1
    s_cbranch_scc1 L_spin135_d
    s_sleep 2
    s_branch L_spin135
L_spin135_d:
    s_mov_b64 exec, -1
    v_mul_u32_u24 v5, 576, v14
    v_lshl_add_u32 v5, v10, 4, v5
    v_add_u32 v5, 140800, v5
    ds_read_b128 v[16:19], v5 offset:0
    ds_read_b128 v[20:23], v5 offset:64
    ds_read_b128 v[24:27], v5 offset:128
    ds_read_b128 v[28:31], v5 offset:192
    ds_read_b128 v[32:35], v5 offset:256
    ds_read_b128 v[36:39], v5 offset:320
    ds_read_b128 v[40:43], v5 offset:384
    ds_read_b128 v[44:47], v5 offset:448
    ds_read_b128 v[48:51], v5 offset:512
    s_mul_i32 s60, s12, 3
    s_add_u32 s60, s60, 0
    s_lshl_b32 s5, s60, 2
    s_add_u32 s5, s5, s4
    s_cmp_ge_u32 s5, 18
    s_cselect_b32 s67, 585728, 0
    s_lshl_b32 s5, s5, 15
    s_sub_u32 s5, s5, s67
    v_bfe_u32 v8, v0, 3, 1
    v_lshl_add_u32 v244, v8, 14, s5
    v_bfe_u32 v8, v0, 4, 1
    v_lshl_add_u32 v244, v8, 13, v244
    v_lshl_add_u32 v244, v14, 4, v244
    s_mul_i32 s60, s12, 3
    s_add_u32 s60, s60, 1
    s_lshl_b32 s5, s60, 2
    s_add_u32 s5, s5, s4
    s_cmp_ge_u32 s5, 18
    s_cselect_b32 s67, 585728, 0
    s_lshl_b32 s5, s5, 15
    s_sub_u32 s5, s5, s67
    v_bfe_u32 v8, v0, 3, 1
    v_lshl_add_u32 v245, v8, 14, s5
    v_bfe_u32 v8, v0, 4, 1
    v_lshl_add_u32 v245, v8, 13, v245
    v_lshl_add_u32 v245, v14, 4, v245
    s_mul_i32 s60, s12, 3
    s_add_u32 s60, s60, 2
    s_lshl_b32 s5, s60, 2
    s_add_u32 s5, s5, s4
    s_cmp_ge_u32 s5, 18
    s_cselect_b32 s67, 585728, 0
    s_lshl_b32 s5, s5, 15
    s_sub_u32 s5, s5, s67
    v_bfe_u32 v8, v0, 3, 1
    v_lshl_add_u32 v246, v8, 14, s5
    v_bfe_u32 v8, v0, 4, 1
    v_lshl_add_u32 v246, v8, 13, v246
    v_lshl_add_u32 v246, v14, 4, v246
    s_add_u32 s65, s65, 2048
    s_waitcnt lgkmcnt(0)
    v_mfma_f32_16x16x32_bf16 v[192:195], v[52:55], v[16:19], 0
    v_mfma_f32_16x16x32_bf16 v[196:199], v[76:79], v[16:19], 0
    v_mfma_f32_16x16x32_bf16 v[200:203], v[100:103], v[16:19], 0
    v_mfma_f32_16x16x32_bf16 v[192:195], v[56:59], v[20:23], v[192:195]
    v_mfma_f32_16x16x32_bf16 v[196:199], v[80:83], v[20:23], v[196:199]
    v_mfma_f32_16x16x32_bf16 v[200:203], v[104:107], v[20:23], v[200:203]
    v_mfma_f32_16x16x32_bf16 v[192:195], v[60:63], v[24:27], v[192:195]
    v_mfma_f32_16x16x32_bf16 v[196:199], v[84:87], v[24:27], v[196:199]
    v_mfma_f32_16x16x32_bf16 v[200:203], v[108:111], v[24:27], v[200:203]
    v_mfma_f32_16x16x32_bf16 v[192:195], v[64:67], v[28:31], v[192:195]
    v_mfma_f32_16x16x32_bf16 v[196:199], v[88:91], v[28:31], v[196:199]
    v_mfma_f32_16x16x32_bf16 v[200:203], v[112:115], v[28:31], v[200:203]
    v_mfma_f32_16x16x32_bf16 v[192:195], v[68:71], v[32:35], v[192:195]
    v_mfma_f32_16x16x32_bf16 v[196:199], v[92:95], v[32:35], v[196:199]
    v_mfma_f32_16x16x32_bf16 v[200:203], v[116:119], v[32:35], v[200:203]
    v_mfma_f32_16x16x32_bf16 v[192:195], v[72:75], v[36:39], v[192:195]
    v_mfma_f32_16x16x32_bf16 v[196:199], v[96:99], v[36:39], v[196:199]
    v_mfma_f32_16x16x32_bf16 v[200:203], v[120:123], v[36:39], v[200:203]
    s_cmp_lg_u32 s4, 2
    s_cbranch_scc1 L_ctl136_d
    s_mov_b32 s70, 2000000
L_ctl136:
    ds_read_b128 v[236:239], v232
    s_waitcnt lgkmcnt(0)
    v_add3_u32 v233, v236, v237, v238
    v_add_u32 v233, v233, v239
    s_nop 0
    v_readfirstlane_b32 s66, v233
    v_lshl_or_b32 v233, v233, 16, s15
    s_mov_b64 exec, 1
    buffer_store_dword v233, v235, s[56:59], s76 offen
    s_mov_b64 exec, -1
    s_cmp_ge_u32 s66, 136
    s_cbranch_scc1 L_ctl136_d
    buffer_load_dword v236, v1, s[56:59], s76 offen sc1
    v_add_u32 v233, 0x10000, v233
    s_waitcnt vmcnt(0)
    v_sub_u32 v236, v236, v233
    v_and_b32 v236, 0x8000ffff, v236
    v_cmp_eq_u32 vcc, 0, v236
    s_bcnt1_i32_b32 s66, vcc_lo
    s_cmp_ge_u32 s66, 16
    s_cselect_b32 s66, 1, 0
    v_mov_b32 v236, s66
    ds_write_b32 v232, v236 offset:16
    s_sub_u32 s70, s70, 1
    s_cbranch_scc0 L_ctl136
L_ctl136_d:
    s_cmp_lg_u32 s4, 3
    s_cbranch_scc1 L_side137
    s_mov_b32 s70, 16000000
L_spin138:
    ds_read_b128 v[236:239], v232
    s_waitcnt lgkmcnt(0)
    v_add3_u32 v233, v236, v237, v238
    v_add_u32 v233, v233, v239
    s_nop 0
    v_readfirstlane_b32 s5, v233
    s_cmp_ge_u32 s5, 96
    s_cbranch_scc1 L_spin138_d
    s_sub_u32 s70, s70, 1
    s_cbranch_scc1 L_spin138_d
    s_sleep 16
    s_branch L_spin138
L_spin138_d:
    s_mov_b64 exec, -1
    v_mov_b32 v234, 0
    s_mov_b32 s70, 2000000
L_poll139:
    buffer_load_dwordx2 v[236:237], v234, s[56:59], 0 offen offset:512 sc1
L_poll139_w:
    s_waitcnt vmcnt(0)
    v_xor_b32 v238, s15, v236
    v_and_b32 v238, 0xfffeffff, v238
    v_xor_b32 v237, s14, v237
    v_or_b32 v238, v238, v237
    v_cmp_ne_u32 vcc, 0, v238
    s_and_b64 exec, exec, vcc
    s_cbranch_scc0 L_poll139_d
    s_sub_u32 s70, s70, 1
    s_cbranch_scc1 L_poll139_d
    s_sleep 16
    s_branch L_poll139
L_poll139_d:
    s_mov_b64 exec, -1
    v_bfe_u32 v236, v236, 16, 1
    v_lshlrev_b32 v236, 13, v236
    ds_write_b32 v232, v236 offset:24
    s_waitcnt lgkmcnt(0)
L_side137:
    s_barrier
    ds_read_b32 v236, v232 offset:24
    s_waitcnt lgkmcnt(0)
    v_xor_b32 v244, v244, v236
    v_xor_b32 v245, v245, v236
    v_xor_b32 v246, v246, v236
    s_barrier
    ds_read_b64_tr_b16 v[52:53], v4 offset:0
    ds_read_b64_tr_b16 v[54:55], v4 offset:512
    ds_read_b64_tr_b16 v[56:57], v4 offset:1024
    ds_read_b64_tr_b16 v[58:59], v4 offset:1536
    ds_read_b64_tr_b16 v[60:61], v4 offset:2048
    ds_read_b64_tr_b16 v[62:63], v4 offset:2560
    ds_read_b64_tr_b16 v[64:65], v4 offset:3072
    ds_read_b64_tr_b16 v[66:67], v4 offset:3584
    ds_read_b64_tr_b16 v[68:69], v4 offset:4096
    ds_read_b64_tr_b16 v[70:71], v4 offset:4608
    ds_read_b64_tr_b16 v[72:73], v4 offset:5120
    ds_read_b64_tr_b16 v[74:75], v4 offset:5632
    ds_read_b64_tr_b16 v[76:77], v4 offset:6144
    ds_read_b64_tr_b16 v[78:79], v4 offset:6656
    ds_read_b64_tr_b16 v[80:81], v4 offset:7168
    ds_read_b64_tr_b16 v[82:83], v4 offset:7680
    ds_read_b64_tr_b16 v[84:85], v4 offset:8192
    ds_read_b64_tr_b16 v[86:87], v4 offset:8704
    s_waitcnt lgkmcnt(12)
    v_mfma_f32_16x16x32_bf16 v[192:195], v[52:55], v[40:43], v[192:195]
    v_mfma_f32_16x16x32_bf16 v[196:199], v[56:59], v[40:43], v[196:199]
    v_mfma_f32_16x16x32_bf16 v[200:203], v[60:63], v[40:43], v[200:203]
    s_waitcnt lgkmcnt(6)
    v_mfma_f32_16x16x32_bf16 v[192:195], v[64:67], v[44:47], v[192:195]
    v_mfma_f32_16x16x32_bf16 v[196:199], v[68:71], v[44:47], v[196:199]
    v_mfma_f32_16x16x32_bf16 v[200:203], v[72:75], v[44:47], v[200:203]
    s_waitcnt lgkmcnt(0)
    v_mfma_f32_16x16x32_bf16 v[192:195], v[76:79], v[48:51], v[192:195]
    v_mfma_f32_16x16x32_bf16 v[196:199], v[80:83], v[48:51], v[196:199]
    v_mfma_f32_16x16x32_bf16 v[200:203], v[84:87], v[48:51], v[200:203]
    s_nop 5
    v_and_or_b32 v192, v192, v12, s6
    ds_bpermute_b32 v208, v15, v192
    v_and_or_b32 v193, v193, v12, s6
    ds_bpermute_b32 v209, v15, v193
    v_and_or_b32 v194, v194, v12, s6
    ds_bpermute_b32 v210, v15, v194
    v_and_or_b32 v195, v195, v12, s6
    ds_bpermute_b32 v211, v15, v195
    v_and_or_b32 v196, v196, v12, s6
    ds_bpermute_b32 v212, v15, v196
    v_and_or_b32 v197, v197, v12, s6
    ds_bpermute_b32 v213, v15, v197
    v_and_or_b32 v198, v198, v12, s6
    ds_bpermute_b32 v214, v15, v198
    v_and_or_b32 v199, v199, v12, s6
    ds_bpermute_b32 v215, v15, v199
    v_and_or_b32 v200, v200, v12, s6
    ds_bpermute_b32 v216, v15, v200
    v_and_or_b32 v201, v201, v12, s6
    ds_bpermute_b32 v217, v15, v201
    v_and_or_b32 v202, v202, v12, s6
    ds_bpermute_b32 v218, v15, v202
    v_and_or_b32 v203, v203, v12, s6
    ds_bpermute_b32 v219, v15, v203
    s_mov_b32 exec_hi, 0
    s_waitcnt lgkmcnt(8)
    buffer_store_dwordx4 v[208:211], v244, s[56:59], s65 offen sc1
    s_waitcnt lgkmcnt(4)
    buffer_store_dwordx4 v[212:215], v245, s[56:59], s65 offen sc1
    s_waitcnt lgkmcnt(0)
    buffer_store_dwordx4 v[216:219], v246, s[56:59], s65 offen sc1
    s_mov_b64 exec, -1
    s_branch L_fin
L_aO:
    s_lshl_b32 s5, s9, 2
    s_add_u32 s5, s5, s4
    s_cmp_ge_u32 s5, 18
    s_cselect_b32 s67, 585728, 0
    s_lshl_b32 s5, s5, 15
    s_sub_u32 s5, s5, s67
    v_bfe_u32 v8, v0, 3, 1
    v_lshl_add_u32 v244, v8, 14, s5
    v_bfe_u32 v8, v0, 4, 1
    v_lshl_add_u32 v244, v8, 13, v244
    v_lshl_add_u32 v244, v14, 4, v244
    v_mul_u32_u24 v6, 640, v10
    v_lshl_add_u32 v5, v11, 4, v6
    s_lshl_b32 s62, s8, 2
    s_add_u32 s62, s62, s4
    s_mul_i32 s62, s62, 2560
    s_add_u32 s62, s62, 458752
    s_mul_i32 s61, s4, 2112
    s_add_u32 s61, s61, 149760
    v_mul_u32_u24 v48, 528, v10
    v_lshl_add_u32 v48, v11, 4, v48
    v_add_u32 v48, s61, v48
    s_lshl_b32 s61, s4, 5
    s_add_u32 s61, s61, 145536
    v_lshl_add_u32 v49, v10, 3, s61
    v_mul_u32_u24 v46, 528, v11
    v_lshl_add_u32 v46, v10, 4, v46
    v_add_u32 v46, 149760, v46
    v_lshlrev_b32 v47, 3, v11
    v_add_u32 v47, 145536, v47
    s_andn2_b32 s74, s2, 6
    s_and_b32 s61, s2, 2
    s_lshl_b32 s61, s61, 1
    s_or_b32 s74, s74, s61
    s_lshl_b32 s74, s74, 12
    s_lshl_b32 s61, s4, 5
    s_add_u32 s74, s74, s61
    s_add_u32 s74, s74, 655360
    v_lshrrev_b32 v8, 1, v0
    v_lshlrev_b32 v7, 7, v8
    v_and_b32 v8, 1, v0
    v_lshl_add_u32 v7, v8, 4, v7
    s_and_b32 s61, s2, 4
    s_lshl_b32 s61, s61, 11
    v_add_u32 v7, s61, v7
    v_mov_b32 v26, 0xff
    s_and_b32 s75, s2, 6
    s_lshr_b32 s61, s4, 1
    s_add_u32 s75, s75, s61
    s_mul_i32 s75, s75, 1152
    s_and_b32 s61, s2, 1
    s_mul_i32 s61, s61, 576
    s_add_u32 s75, s75, s61
    s_lshr_b32 s61, s2, 3
    s_lshl_b32 s61, s61, 5
    s_add_u32 s75, s75, s61
    s_and_b32 s61, s4, 1
    s_lshl_b32 s61, s61, 4
    s_add_u32 s75, s75, s61
    v_and_b32 v9, 1, v10
    v_lshlrev_b32 v9, 1, v9
    v_lshl_add_u32 v13, v8, 3, v9
    v_bfe_u32 v9, v0, 3, 1
    v_lshl_add_u32 v13, v9, 2, v13
    buffer_load_ushort v50, v13, s[40:43], s75 offen
    s_lshr_b32 s61, s9, 1
    s_and_b32 s60, s9, 1
    s_lshl_b32 s60, s60, 3
    s_add_u32 s61, s61, s60
    s_lshl_b32 s60, s4, 2
    s_sub_u32 s61, s61, s60
    v_cmp_ne_u32 s[72:73], s61, v10
    s_mov_b32 s48, s34
    s_mov_b32 s49, s35
    s_mov_b32 s50, 9216
    s_mov_b32 s51, 0x20000
    s_cmp_lg_u32 s4, 2
    s_cbranch_scc1 L_ctl140_d
    s_mov_b32 s70, 2000000
L_ctl140:
    ds_read_b128 v[236:239], v232
    s_waitcnt lgkmcnt(0)
    v_add3_u32 v233, v236, v237, v238
    v_add_u32 v233, v233, v239
    s_nop 0
    v_readfirstlane_b32 s66, v233
    v_lshl_or_b32 v233, v233, 16, s15
    s_mov_b64 exec, 1
    buffer_store_dword v233, v235, s[56:59], s76 offen
    s_mov_b64 exec, -1
    s_cmp_ge_u32 s66, 136
    s_cbranch_scc1 L_ctl140_d
    buffer_load_dword v236, v1, s[56:59], s76 offen sc1
    v_add_u32 v233, 0x10000, v233
    s_waitcnt vmcnt(0)
    v_sub_u32 v236, v236, v233
    v_and_b32 v236, 0x8000ffff, v236
    v_cmp_eq_u32 vcc, 0, v236
    s_bcnt1_i32_b32 s66, vcc_lo
    s_cmp_ge_u32 s66, 16
    s_cselect_b32 s66, 1, 0
    v_mov_b32 v236, s66
    ds_write_b32 v232, v236 offset:16
    s_sub_u32 s70, s70, 1
    s_cbranch_scc0 L_ctl140
L_ctl140_d:
    s_cmp_lg_u32 s4, 3
    s_cbranch_scc1 L_side141
    s_mov_b32 s70, 16000000
L_spin142:
    ds_read_b128 v[236:239], v232
    s_waitcnt lgkmcnt(0)
    v_add3_u32 v233, v236, v237, v238
    v_add_u32 v233, v233, v239
    s_nop 0
    v_readfirstlane_b32 s5, v233
    s_cmp_ge_u32 s5, 96
    s_cbranch_scc1 L_spin142_d
    s_sub_u32 s70, s70, 1
    s_cbranch_scc1 L_spin142_d
    s_sleep 16
    s_branch L_spin142
L_spin142_d:
    s_mov_b64 exec, -1
    v_mov_b32 v234, 0
    s_mov_b32 s70, 2000000
L_poll143:
    buffer_load_dwordx2 v[236:237], v234, s[56:59], 0 offen offset:512 sc1
L_poll143_w:
    s_waitcnt vmcnt(0)
    v_xor_b32 v238, s15, v236
    v_and_b32 v238, 0xfffeffff, v238
    v_xor_b32 v237, s14, v237
    v_or_b32 v238, v238, v237
    v_cmp_ne_u32 vcc, 0, v238
    s_and_b64 exec, exec, vcc
    s_cbranch_scc0 L_poll143_d
    s_sub_u32 s70, s70, 1
    s_cbranch_scc1 L_poll143_d
    s_sleep 16
    s_branch L_poll143
L_poll143_d:
    s_mov_b64 exec, -1
    v_bfe_u32 v236, v236, 16, 1
    v_lshlrev_b32 v236, 13, v236
    ds_write_b32 v232, v236 offset:24
    s_waitcnt lgkmcnt(0)
L_side141:
    s_waitcnt vmcnt(0)
    v_lshlrev_b32 v50, 16, v50
    s_mov_b64 exec, s[72:73]
    s_barrier
    buffer_load_dwordx4 v[28:31], v5, s[56:59], s62 offen sc1
    buffer_load_dwordx4 v[32:35], v5, s[56:59], s62 offen offset:256 sc1
    buffer_load_dwordx2 v[36:37], v6, s[56:59], s62 offen offset:512 sc1
    s_waitcnt vmcnt(0)
    v_max3_u32 v38, v28, v29, v30
    v_max3_u32 v38, v38, v31, v32
    v_max3_u32 v38, v38, v33, v34
    v_max3_u32 v38, v38, v35, v36
    v_max_u32 v38, v38, v37
    v_cmp_eq_u32 vcc, -1, v38
    s_cbranch_vccnz L_og1
    ds_write_b128 v48, v[28:31]
    ds_write_b128 v48, v[32:35] offset:256
    ds_write_b64 v49, v[36:37]
    s_mov_b64 exec, -1
    ds_read_b32 v236, v232 offset:24
    s_barrier
    ds_read_b64_tr_b16 v[160:161], v4 offset:0
    ds_read_b64_tr_b16 v[162:163], v4 offset:512
    ds_read_b64_tr_b16 v[164:165], v4 offset:1024
    ds_read_b64_tr_b16 v[166:167], v4 offset:1536
    ds_read_b64_tr_b16 v[168:169], v4 offset:2048
    ds_read_b64_tr_b16 v[170:171], v4 offset:2560
    ds_read_b64_tr_b16 v[172:173], v4 offset:3072
    ds_read_b64_tr_b16 v[174:175], v4 offset:3584
    ds_read_b64_tr_b16 v[176:177], v4 offset:4096
    ds_read_b64_tr_b16 v[178:179], v4 offset:4608
    ds_read_b64_tr_b16 v[180:181], v4 offset:5120
    ds_read_b64_tr_b16 v[182:183], v4 offset:5632
    ds_read_b64_tr_b16 v[184:185], v4 offset:6144
    ds_read_b64_tr_b16 v[186:187], v4 offset:6656
    ds_read_b64_tr_b16 v[188:189], v4 offset:7168
    ds_read_b64_tr_b16 v[190:191], v4 offset:7680
    s_branch L_og2
L_og1:
    s_mov_b64 exec, vcc
    s_mov_b32 s70, 2000000
    buffer_load_dwordx4 v[28:31], v5, s[56:59], s62 offen sc1
    buffer_load_dwordx4 v[32:35], v5, s[56:59], s62 offen offset:256 sc1
    buffer_load_dwordx2 v[36:37], v6, s[56:59], s62 offen offset:512 sc1
    s_mov_b64 exec, -1
    ds_read_b32 v236, v232 offset:24
    s_barrier
    ds_read_b64_tr_b16 v[160:161], v4 offset:0
    ds_read_b64_tr_b16 v[162:163], v4 offset:512
    ds_read_b64_tr_b16 v[164:165], v4 offset:1024
    ds_read_b64_tr_b16 v[166:167], v4 offset:1536
    ds_read_b64_tr_b16 v[168:169], v4 offset:2048
    ds_read_b64_tr_b16 v[170:171], v4 offset:2560
    ds_read_b64_tr_b16 v[172:173], v4 offset:3072
    ds_read_b64_tr_b16 v[174:175], v4 offset:3584
    ds_read_b64_tr_b16 v[176:177], v4 offset:4096
    ds_read_b64_tr_b16 v[178:179], v4 offset:4608
    ds_read_b64_tr_b16 v[180:181], v4 offset:5120
    ds_read_b64_tr_b16 v[182:183], v4 offset:5632
    ds_read_b64_tr_b16 v[184:185], v4 offset:6144
    ds_read_b64_tr_b16 v[186:187], v4 offset:6656
    ds_read_b64_tr_b16 v[188:189], v4 offset:7168
    ds_read_b64_tr_b16 v[190:191], v4 offset:7680
    s_mov_b64 exec, vcc
    s_branch L_poll144_w
L_poll144:
    buffer_load_dwordx4 v[28:31], v5, s[56:59], s62 offen sc1
    buffer_load_dwordx4 v[32:35], v5, s[56:59], s62 offen offset:256 sc1
    buffer_load_dwordx2 v[36:37], v6, s[56:59], s62 offen offset:512 sc1
L_poll144_w:
    s_waitcnt vmcnt(0)
    v_max3_u32 v38, v28, v29, v30
    v_max3_u32 v38, v38, v31, v32
    v_max3_u32 v38, v38, v33, v34
    v_max3_u32 v38, v38, v35, v36
    v_max_u32 v38, v38, v37
    v_cmp_eq_u32 vcc, -1, v38
    s_and_b64 exec, exec, vcc
    s_cbranch_scc0 L_poll144_d
    s_sub_u32 s70, s70, 1
    s_cbranch_scc1 L_poll144_d
    s_branch L_poll144
L_poll144_d:
    s_mov_b64 exec, s[72:73]
    ds_write_b128 v48, v[28:31]
    ds_write_b128 v48, v[32:35] offset:256
    ds_write_b64 v49, v[36:37]
    s_mov_b64 exec, -1
L_og2:
    s_waitcnt lgkmcnt(0)
    s_barrier
    ds_read_b64 v[36:37], v47
    ds_read_b128 v[52:55], v46 offset:0
    ds_read_b128 v[68:71], v46 offset:256
    ds_read_b128 v[56:59], v46 offset:64
    ds_read_b128 v[72:75], v46 offset:320
    ds_read_b128 v[60:63], v46 offset:128
    ds_read_b128 v[76:79], v46 offset:384
    ds_read_b128 v[64:67], v46 offset:192
    ds_read_b128 v[80:83], v46 offset:448
    s_waitcnt lgkmcnt(8)
    v_sub_f32_dpp v38, v36, v36 row_ror:8 row_mask:0xf bank_mask:0xf
    v_sub_f32_dpp v39, v37, v37 row_ror:8 row_mask:0xf bank_mask:0xf
    s_waitcnt lgkmcnt(7)
    v_mfma_f32_16x16x32_bf16 v[192:195], v[160:163], v[52:55], 0
    v_exp_f32 v38, v38
    s_waitcnt lgkmcnt(6)
    v_mfma_f32_16x16x32_bf16 v[196:199], v[176:179], v[68:71], 0
    v_exp_f32 v39, v39
    s_waitcnt lgkmcnt(5)
    v_mfma_f32_16x16x32_bf16 v[192:195], v[164:167], v[56:59], v[192:195]
    v_add_f32 v38, 1.0, v38
    s_waitcnt lgkmcnt(4)
    v_mfma_f32_16x16x32_bf16 v[196:199], v[180:183], v[72:75], v[196:199]
    v_add_f32 v39, 1.0, v39
    s_waitcnt lgkmcnt(3)
    v_mfma_f32_16x16x32_bf16 v[192:195], v[168:171], v[60:63], v[192:195]
    v_rcp_f32 v38, v38
    s_waitcnt lgkmcnt(2)
    v_mfma_f32_16x16x32_bf16 v[196:199], v[184:187], v[76:79], v[196:199]
    v_rcp_f32 v39, v39
    s_waitcnt lgkmcnt(1)
    v_mfma_f32_16x16x32_bf16 v[192:195], v[172:175], v[64:67], v[192:195]
    v_xor_b32 v244, v244, v236
    s_waitcnt lgkmcnt(0)
    v_mfma_f32_16x16x32_bf16 v[196:199], v[188:191], v[80:83], v[196:199]
    v_xor_b32 v7, v7, v236
    s_nop 3
    v_mul_f32 v192, v192, v38
    v_mul_f32 v193, v193, v38
    v_mul_f32 v194, v194, v38
    v_mul_f32 v195, v195, v38
    v_fmac_f32 v192, v196, v39
    v_fmac_f32 v193, v197, v39
    v_fmac_f32 v194, v198, v39
    v_fmac_f32 v195, v199, v39
    v_add_f32_dpp v192, v192, v192 row_ror:8 row_mask:0xf bank_mask:0xf
    v_add_f32_dpp v193, v193, v193 row_ror:8 row_mask:0xf bank_mask:0xf
    v_add_f32_dpp v194, v194, v194 row_ror:8 row_mask:0xf bank_mask:0xf
    v_add_f32_dpp v195, v195, v195 row_ror:8 row_mask:0xf bank_mask:0xf
    v_and_or_b32 v192, v192, v12, s6
    ds_bpermute_b32 v208, v15, v192
    v_and_or_b32 v193, v193, v12, s6
    ds_bpermute_b32 v209, v15, v193
    v_and_or_b32 v194, v194, v12, s6
    ds_bpermute_b32 v210, v15, v194
    v_and_or_b32 v195, v195, v12, s6
    ds_bpermute_b32 v211, v15, v195
    s_mov_b32 exec_hi, 0
    s_waitcnt lgkmcnt(0)
    buffer_store_dwordx4 v[208:211], v244, s[56:59], s65 offen sc1
    s_mov_b64 exec, -1
    s_waitcnt vmcnt(0)
    s_mov_b32 s70, 2000000
L_poll145:
    buffer_load_dwordx4 v[16:19], v7, s[56:59], s74 offen sc1
L_poll145_w:
    s_waitcnt vmcnt(0)
    v_xor_b32 v16, s6, v16
    v_xor_b32 v17, s6, v17
    v_xor_b32 v18, s6, v18
    v_xor_b32 v19, s6, v19
    v_or3_b32 v24, v16, v17, v18
    v_bitop3_b32 v24, v24, v26, v19 bitop3:0xc8
    v_cmp_ne_u32 vcc, 0, v24
    s_cbranch_vccz L_poll145_d
    s_sub_u32 s70, s70, 1
    s_cbranch_scc1 L_poll145_d
    s_wqm_b64 exec, vcc
    s_branch L_poll145
L_poll145_d:
    s_mov_b64 exec, -1
    v_permlane16_swap_b32 v16, v17
    v_permlane16_swap_b32 v18, v19
    v_add_f32 v17, v16, v17
    v_add_f32 v18, v18, v19
    s_nop 0
    v_add_f32_dpp v16, v17, v17 row_ror:8 row_mask:0xf bank_mask:0x3
    v_add_f32_dpp v16, v18, v18 row_ror:8 row_mask:0xf bank_mask:0xc
    s_nop 1
    v_add_f32_dpp v16, v16, v16 row_shl:4 row_mask:0xf bank_mask:0x5
    s_nop 1
    v_add_f32_dpp v16, v16, v16 quad_perm:[2,3,0,1] row_mask:0xf bank_mask:0xf
    v_cvt_pk_bf16_f32 v16, v16, v16
    v_lshlrev_b32 v16, 16, v16
    v_add_f32 v17, v16, v50
    v_cvt_pk_bf16_f32 v17, v17, v17
    v_lshlrev_b32 v17, 16, v17
    v_permlane32_swap_b32 v16, v18
    v_add_f32 v17, v17, v18
    v_cvt_pk_bf16_f32 v17, v17, v17
    s_mov_b32 exec_lo, 0x03030303
    s_mov_b32 exec_hi, 0
    buffer_store_short v17, v13, s[48:51], s75 offen
    s_mov_b32 exec_lo, -1
    s_add_u32 s60, s2, s4
    s_cmp_lg_u32 s60, 0
    s_cbranch_scc1 L_o3
    v_mov_b32 v19, s14
    buffer_store_dword v19, v1, s[56:59], 0 offen
L_o3:
L_fin:
L_end:
    s_endpgm
.section .rodata,"a"
.p2align 6
.amdhsa_kernel parallel_sum__sliding_block_cached__geglu_ffn__decode_kernel
.amdhsa_next_free_vgpr 256
.amdhsa_next_free_sgpr 102
.amdhsa_accum_offset 256
.amdhsa_group_segment_fixed_size 0
.amdhsa_kernarg_size 96
.amdhsa_user_sgpr_count 2
.amdhsa_user_sgpr_kernarg_segment_ptr 1
.amdhsa_system_sgpr_workgroup_id_x 1
.amdhsa_float_denorm_mode_32 3
.end_amdhsa_kernel
```
